```python
import torch

def _softmax(x, axis=-1):
    return torch.softmax(x, dim=axis)
def _gelu(x):
    return torch.nn.functional.gelu(x, approximate="tanh")
def _silu(x):
    return torch.nn.functional.silu(x)
def _sigmoid(x):
    return torch.sigmoid(x)
def _layernorm(x, axis=-1, eps=1e-5):
    m = x.mean(dim=axis, keepdim=True)
    v = x.var(dim=axis, keepdim=True, unbiased=False)
    return (x - m) / torch.sqrt(v + eps)
def _scatter_add(tgt, idx, src, axis=0):
    return tgt.clone().index_add_(axis, idx, src)
def _segment_sum(src, seg, n):
    out = torch.zeros((n,) + src.shape[1:], dtype=src.dtype)
    return out.index_add_(0, seg, src)
def _pad(x, pw):
    flat = tuple(v for pair in reversed(pw) for v in pair)
    return torch.nn.functional.pad(x, flat)

kernel_name = 'interleave_layers__spectral_fnet__spectral_fnet__prompt'

def setup_inputs():

    _w = (lambda a: (lambda t: t.to(torch.bfloat16) if t.is_floating_point() else t)(torch.as_tensor(a)))
    def _A_setup():
        B, S, D = 1, 2048, 640
        ns = torch.arange(S)[:, None] * torch.arange(S)[None, :]
        nd = torch.arange(D)[:, None] * torch.arange(D)[None, :]
        Ws_re = torch.cos(-2.0 * torch.pi * ns / S).to(float)
        Ws_im = torch.sin(-2.0 * torch.pi * ns / S).to(float)
        Wd_re = torch.cos(-2.0 * torch.pi * nd / D).to(float)
        Wd_im = torch.sin(-2.0 * torch.pi * nd / D).to(float)
        return {
            "x": _w((lambda *s: torch.randn(*s, dtype=torch.bfloat16) * 0.05)(B, S, D)),
            "dft_seq_re": _w(Ws_re),
            "dft_seq_im": _w(Ws_im),
            "dft_hid_re": _w(Wd_re),
            "dft_hid_im": _w(Wd_im),
        }
    _A_in = _A_setup()

    def _B_setup():
        B, S, D = 1, 2048, 640
        ns = torch.arange(S)[:, None] * torch.arange(S)[None, :]
        nd = torch.arange(D)[:, None] * torch.arange(D)[None, :]
        Ws_re = torch.cos(-2.0 * torch.pi * ns / S).to(float)
        Ws_im = torch.sin(-2.0 * torch.pi * ns / S).to(float)
        Wd_re = torch.cos(-2.0 * torch.pi * nd / D).to(float)
        Wd_im = torch.sin(-2.0 * torch.pi * nd / D).to(float)
        return {
            "x": _w((lambda *s: torch.randn(*s, dtype=torch.bfloat16) * 0.05)(B, S, D)),
            "dft_seq_re": _w(Ws_re),
            "dft_seq_im": _w(Ws_im),
            "dft_hid_re": _w(Wd_re),
            "dft_hid_im": _w(Wd_im),
        }
    _B_in = _B_setup()

    return {
        "A_x": _A_in["x"],
        "A_dft_seq_re": _A_in["dft_seq_re"],
        "A_dft_seq_im": _A_in["dft_seq_im"],
        "A_dft_hid_re": _A_in["dft_hid_re"],
        "A_dft_hid_im": _A_in["dft_hid_im"],
        "B_x": _B_in["x"],
        "B_dft_seq_re": _B_in["dft_seq_re"],
        "B_dft_seq_im": _B_in["dft_seq_im"],
        "B_dft_hid_re": _B_in["dft_hid_re"],
        "B_dft_hid_im": _B_in["dft_hid_im"],
    }

def reference(A_x, A_dft_seq_re, A_dft_seq_im, A_dft_hid_re, A_dft_hid_im, B_x, B_dft_seq_re, B_dft_seq_im, B_dft_hid_re, B_dft_hid_im):
    def _A_ref(x, dft_seq_re, dft_seq_im, dft_hid_re, dft_hid_im):
        a = torch.einsum("bsd,ed->bse", x, dft_hid_re)
        b = torch.einsum("bsd,ed->bse", x, dft_hid_im)
        y = torch.einsum("ts,bse->bte", dft_seq_re, a) - torch.einsum("ts,bse->bte", dft_seq_im, b)
        return y

    def _B_ref(x, dft_seq_re, dft_seq_im, dft_hid_re, dft_hid_im):
        a = torch.einsum("bsd,ed->bse", x, dft_hid_re)
        b = torch.einsum("bsd,ed->bse", x, dft_hid_im)
        y = torch.einsum("ts,bse->bte", dft_seq_re, a) - torch.einsum("ts,bse->bte", dft_seq_im, b)
        return y

    x = A_x
    x = x + _A_ref(_layernorm(x, axis=-1), A_dft_seq_re, A_dft_seq_im, A_dft_hid_re, A_dft_hid_im)
    x = x + _B_ref(_layernorm(x, axis=-1), B_dft_seq_re, B_dft_seq_im, B_dft_hid_re, B_dft_hid_im)
    x = x + _A_ref(_layernorm(x, axis=-1), A_dft_seq_re, A_dft_seq_im, A_dft_hid_re, A_dft_hid_im)
    x = x + _B_ref(_layernorm(x, axis=-1), B_dft_seq_re, B_dft_seq_im, B_dft_hid_re, B_dft_hid_im)
    return x
```

```asm
; @launch grid=(256,1,1) block=(320,1,1) lds=50176
.amdgcn_target "amdgcn-amd-amdhsa--gfx950"
.text
.globl interleave_layers__spectral_fnet__spectral_fnet__prompt_kernel
.p2align 8
.type interleave_layers__spectral_fnet__spectral_fnet__prompt_kernel,@function
interleave_layers__spectral_fnet__spectral_fnet__prompt_kernel:
  s_load_dwordx2 s[16:17], s[0:1], 96
  s_load_dwordx2 s[8:9], s[0:1], 0
  s_load_dwordx2 s[12:13], s[0:1], 80
  v_lshrrev_b32_e64 v193, 6, v0
  s_cmp_ge_u32 s2, 256
  s_cbranch_scc1 L_end
  s_getpc_b64 s[24:25]
  v_lshlrev_b32_e64 v194, 7, v0
  v_min_u32 v194, L_codeend-interleave_layers__spectral_fnet__spectral_fnet__prompt_kernel-64, v194
  global_load_dword v255, v194, s[24:25]
  v_readfirstlane_b32 s3, v193
  v_and_b32 v192, 63, v0
  s_and_b32 s4, s2, 7
  s_lshr_b32 s5, s2, 3
  v_lshlrev_b32_e64 v1, 4, v192
  s_mov_b32 s18, 9502720
  s_mov_b32 s19, 0x20000
  s_mov_b32 s14, 2621440
  s_mov_b32 s15, 0x20000
  s_cmp_eq_u32 s3, 4
  s_cbranch_scc0 L_main
L_hk:
  s_setprio 3
  v_mov_b32 v4, 0
  v_mov_b32 v5, 0
  v_mov_b32 v6, 0
  v_mov_b32 v7, 0
  s_lshl_b32 s46, s4, 5
  s_add_u32 s46, s46, s5
  s_lshl_b32 s97, s46, 4
  s_add_u32 s97, s97, 4096
  s_mul_i32 s94, s46, 5120
  s_add_u32 s44, s94, 5570560
  s_add_u32 s94, s94, 262144
  v_lshlrev_b32_e64 v26, 8, v1
  s_mov_b64 exec, 3
  s_waitcnt lgkmcnt(0)
  buffer_load_dword v24, v26, s[16:19], s97 offen
  s_mov_b64 exec, -1
  v_lshlrev_b32 v12, 3, v1
  v_min_u32 v29, 4992, v12
  s_lshl_b32 s7, s4, 9
  s_nop 0
  s_add_u32 s7, s7, 12288
  buffer_load_dword v35, v29, s[16:19], s94 offen
  v_min_u32 v29, 384, v12
  buffer_load_dword v36, v29, s[16:19], s7 offen
  s_branch L_hk2
L_main:
  s_lshl_b32 s6, s4, 2
  s_lshr_b32 s6, 0x9654d210, s6
  s_and_b32 s6, s6, 15
  s_lshl_b32 s26, s5, 4
  s_add_u32 s26, s26, s6
  s_cmp_eq_u32 s4, 0
  s_cselect_b32 s7, 248, 0
  s_cmp_ge_u32 s5, 16
  s_cselect_b32 s7, s7, 0
  s_sub_u32 s26, s26, s7
  s_and_b32 s27, s26, 1
  s_getpc_b64 s[24:25]
  s_add_u32 s24, s24, tbl@rel32@lo+4
  s_addc_u32 s25, s25, tbl@rel32@hi+12
  s_lshr_b32 s7, s26, 7
  s_lshl_b32 s94, s27, 2
  s_sub_u32 s7, s7, s94
  s_add_u32 s7, s7, 26
  s_cmp_eq_u32 s26, 128
  s_cselect_b32 s7, 30, s7
  s_cmp_eq_u32 s26, 0
  s_cselect_b32 s7, 31, s7
  s_cselect_b32 s94, 16384, 0
  s_lshl_b32 s7, s7, 10
  s_lshl_b32 s95, s3, 12
  s_cmp_eq_u32 s3, 0
  s_cselect_b32 s94, s94, s95
  s_cmp_eq_u32 s3, 1
  s_cselect_b32 s7, s7, s94
  s_add_u32 m0, s95, 25600
  v_add_u32 v194, s94, v1
  v_add_u32_e64 v195, s7, v1
  s_lshl_b32 s7, s27, 12
  s_add_u32 s7, s7, 32768
  global_load_lds_dwordx4 v195, s[24:25]
  global_load_lds_dwordx4 v194, s[24:25] offset:1024
  global_load_lds_dwordx4 v194, s[24:25] offset:2048
  global_load_lds_dwordx4 v194, s[24:25] offset:3072
  v_lshl_add_u32 v194, v0, 4, s7
  global_load_dwordx3 v[16:18], v194, s[24:25]
  s_or_b32 s41, s2, s3
  s_cmp_lg_u32 s41, 0
  s_cbranch_scc1 L_nodel
  s_nop 0
  v_add_u32 v194, 20480, v1
  global_load_dwordx4 v[172:175], v194, s[24:25]
  global_load_dwordx4 v[176:179], v194, s[24:25] offset:1024
L_nodel:
  s_sub_u32 s92, 0, s26
  s_and_b32 s92, s92, 511
  s_cmp_eq_u32 s26, 0
  s_cselect_b32 s92, 256, s92
  s_mul_i32 s92, s92, 1280
  s_mul_i32 s93, s26, 1280
  s_sub_u32 s92, s92, s93
  s_nop 0
  s_sub_u32 s92, s92, 2621440
  s_mov_b32 s10, 2621440
  s_mov_b32 s11, 0x20000
  s_mov_b32 s96, 0x9fb00
  v_lshlrev_b32_e64 v7, 4, v0
  v_mul_u32_u24 v204, 205, v0
  v_lshrrev_b32 v204, 14, v204
  v_mov_b32 v205, s92
  v_cmp_le_u32_e64 vcc, 4, v204
  v_mad_u32_u24 v204, v204, s96, v7
  s_nop 0
  v_cndmask_b32 v205, 0, v205, vcc
  v_add3_u32 v28, v204, v205, s93
  s_add_u32 s93, s93, 4096
  v_add_u32 v204, 256, v0
  v_mul_u32_u24 v204, 205, v204
  v_lshrrev_b32 v204, 14, v204
  v_mov_b32 v205, s92
  v_cmp_le_u32_e64 vcc, 4, v204
  v_mad_u32_u24 v204, v204, s96, v7
  s_nop 0
  v_cndmask_b32 v205, 0, v205, vcc
  v_add3_u32 v29, v204, v205, s93
  s_add_u32 s93, s93, 4096
  v_add_u32 v204, 512, v0
  v_mul_u32_u24 v204, 205, v204
  v_lshrrev_b32 v204, 14, v204
  v_mov_b32 v205, s92
  v_cmp_le_u32_e64 vcc, 4, v204
  v_mad_u32_u24 v204, v204, s96, v7
  s_nop 0
  v_cndmask_b32 v205, 0, v205, vcc
  v_add3_u32 v30, v204, v205, s93
  s_waitcnt lgkmcnt(0)
  s_lshl_b32 s7, s3, 10
  s_add_u32 m0, s7, 15360
  s_nop 1
  buffer_load_dwordx4 v28, s[8:11], 0 offen nt lds
  s_add_u32 m0, s7, 19456
  s_cmp_ge_u32 s3, 2
  buffer_load_dwordx4 v29, s[8:11], 0 offen nt lds
  s_cbranch_scc1 L_nox2
  s_add_u32 m0, s7, 23552
  s_nop 0
  buffer_load_dwordx4 v30, s[8:11], 0 offen nt lds
  s_branch L_x2
L_nox2:
  v_mov_b32 v30, 1073741824
  buffer_load_dword v254, v30, s[8:11], 0 offen
L_x2:
  v_and_b32_e64 v202, 15, v0
  v_bfe_u32 v203, v0, 4, 2
  s_mul_i32 s94, s27, 320
  v_lshrrev_b32 v205, 1, v203
  v_mul_u32_u24_e64 v206, s94, v205
  s_lshl_b32 s92, s3, 5
  v_add3_u32 v204, v202, v206, s92
  s_and_b32 s92, s3, 1
  s_lshl_b32 s92, s92, 3
  s_lshr_b32 s93, s3, 1
  s_lshl_b32 s93, s93, 5
  s_add_u32 s92, s92, s93
  s_add_u32 s92, s92, 256
  v_lshrrev_b32 v209, 1, v202
  v_and_b32_e64 v210, 1, v0
  v_add3_u32 v209, v209, v206, s92
  v_lshl_add_u32 v209, v210, 4, v209
  s_xor_b32 s94, s27, 1
  v_and_b32 v205, s94, v205
  v_xor_b32 v205, v205, v203
  v_add_u32 v206, 16, v204
  v_and_b32_e64 v205, 1, v205
  v_add_u32 v207, 128, v204
  v_cmp_eq_u32_e64 vcc, 1, v205
  v_add_u32 v208, 144, v204
  s_mul_i32 s94, s94, 320
  v_sub_u32 v210, 640, v204
  v_sub_u32 v211, 640, v206
  v_sub_u32 v212, 640, v207
  v_sub_u32 v213, 640, v208
  v_sub_u32 v214, 640, v209
  v_cndmask_b32 v22, v204, v210, vcc
  v_cndmask_b32 v23, v206, v211, vcc
  v_cndmask_b32 v24, v207, v212, vcc
  v_cndmask_b32 v25, v208, v213, vcc
  v_cndmask_b32 v26, v209, v214, vcc
  v_cmp_gt_u32 vcc, 2, v203
  v_mov_b32 v209, s94
  v_and_b32 v205, 1, v203
  v_cndmask_b32 v209, 0, v209, vcc
  v_cmp_eq_u32 vcc, 0, v204
  v_mul_u32_u24 v201, 0x1400, v205
  v_add_u32 v206, 15360, v201
  v_cndmask_b32 v22, v22, v209, vcc
  v_cmp_ne_u32 vcc, 0, v22
  v_lshl_add_u32 v22, v22, 1, v206
  v_lshl_add_u32 v23, v23, 1, v206
  v_lshl_add_u32 v24, v24, 1, v206
  v_lshl_add_u32 v25, v25, 1, v206
  v_lshl_add_u32 v26, v26, 1, v206
  v_cndmask_b32 v27, 0, -1, vcc
  v_mov_b32 v32, 0
  v_mov_b32 v33, 0
  v_mov_b32 v34, 0
  v_mov_b32 v35, 0
  v_mov_b32 v36, 0
  v_mov_b32 v37, 0
  v_mov_b32 v38, 0
  v_mov_b32 v39, 0
  v_mov_b32 v40, 0
  v_mov_b32 v41, 0
  v_mov_b32 v42, 0
  v_mov_b32 v43, 0
  v_mov_b32 v44, 0
  v_mov_b32 v45, 0
  v_mov_b32 v46, 0
  v_mov_b32 v47, 0
  v_mov_b32 v48, 0
  v_mov_b32 v49, 0
  v_mov_b32 v50, 0
  v_mov_b32 v51, 0
  v_mov_b32 v248, 0
  v_mov_b32 v249, 0
  v_mov_b32 v250, 0
  v_mov_b32 v251, 0
  s_lshr_b32 s95, s5, 3
  s_lshl_b32 s7, s95, 2
  s_lshr_b32 s7, 0x1120, s7
  s_and_b32 s7, s7, 3
  s_add_u32 s96, s6, 256
  s_cmp_eq_u32 s4, 0
  s_cselect_b32 s96, 8, s96
  s_lshl_b32 s94, s3, 4
  s_add_u32 s6, s6, s94
  s_add_u32 s96, s96, s94
  v_lshl_add_u32 v205, v202, 2, s7
  v_lshl_add_u32 v206, v203, 6, s6
  v_lshl_add_u32 v207, v203, 6, s96
  v_add_u32_e64 v204, 64, v205
  s_mov_b32 s94, 0x3a000000
  v_mul_u32_u24 v216, v205, v206
  v_mul_u32_u24 v218, v205, v207
  v_mul_u32_u24 v220, v204, v206
  v_mul_u32_u24 v222, v204, v207
  v_and_b32 v216, 0x7ff, v216
  v_and_b32 v218, 0x7ff, v218
  v_and_b32 v220, 0x7ff, v220
  v_and_b32 v222, 0x7ff, v222
  v_cvt_f32_u32 v216, v216
  v_cvt_f32_u32 v218, v218
  v_cvt_f32_u32 v220, v220
  v_cvt_f32_u32 v222, v222
  v_mul_f32 v216, s94, v216
  v_mul_f32 v218, s94, v218
  v_mul_f32 v220, s94, v220
  v_mul_f32 v222, s94, v222
  v_sin_f32 v217, v216
  v_cos_f32 v216, v216
  v_sin_f32 v219, v218
  v_cos_f32 v218, v218
  v_sin_f32 v221, v220
  v_cos_f32 v220, v220
  v_sin_f32 v223, v222
  v_cos_f32 v222, v222
  v_cvt_pk_f16_f32 v224, v216, v217
  v_cvt_pk_f16_f32 v225, -v217, v216
  v_cvt_pk_f16_f32 v226, v218, v219
  v_cvt_pk_f16_f32 v227, -v219, v218
  v_cvt_pk_f16_f32 v228, v220, v221
  v_cvt_pk_f16_f32 v229, -v221, v220
  v_cvt_pk_f16_f32 v230, v222, v223
  v_cvt_pk_f16_f32 v231, -v223, v222
  s_cmp_lg_u32 s4, 0
  s_cbranch_scc1 L_cm_done
  v_mov_b32 v225, 0
  v_mov_b32 v227, v226
  v_mov_b32 v226, 0
  v_mov_b32 v229, 0
  v_mov_b32 v231, v230
  v_mov_b32 v230, 0
  v_and_b32 v209, 1, v0
  v_lshlrev_b32 v209, 4, v209
  v_mov_b32 v210, 0x3c00
  v_lshlrev_b32 v209, v209, v210
  v_cmp_gt_u32 vcc, 16, v0
  s_nop 1
  v_cndmask_b32 v224, v224, v209, vcc
  v_cndmask_b32 v228, v228, v209, vcc
L_cm_done:
  v_lshlrev_b32 v204, 2, v203
  v_mul_u32_u24 v204, v204, v202
  v_cvt_f32_u32 v204, v204
  v_cvt_f32_u32_e64 v205, v202
  v_mul_f32 v204, 0x3acccccd, v204
  v_mul_f32 v205, 0x3acccccd, v205
  v_cos_f32 v80, v204
  v_sin_f32 v92, v204
  v_fmamk_f32 v206, v205, 0x3f800000, v204
  v_cos_f32 v81, v206
  v_sin_f32 v93, v206
  v_fmamk_f32 v206, v205, 0x40000000, v204
  v_cos_f32 v82, v206
  v_sin_f32 v94, v206
  v_fmamk_f32 v206, v205, 0x40400000, v204
  v_cos_f32 v83, v206
  v_sin_f32 v95, v206
  v_fmamk_f32 v206, v205, 0x41800000, v204
  v_cos_f32 v84, v206
  v_sin_f32 v96, v206
  v_fmamk_f32 v206, v205, 0x41880000, v204
  v_cos_f32 v85, v206
  v_sin_f32 v97, v206
  v_fmamk_f32 v206, v205, 0x41900000, v204
  v_cos_f32 v86, v206
  v_sin_f32 v98, v206
  v_fmamk_f32 v206, v205, 0x41980000, v204
  v_cos_f32 v87, v206
  v_sin_f32 v99, v206
  v_fmamk_f32 v206, v205, 0x42000000, v204
  v_cos_f32 v88, v206
  v_sin_f32 v100, v206
  v_fmamk_f32 v206, v205, 0x42040000, v204
  v_cos_f32 v89, v206
  v_sin_f32 v101, v206
  v_fmamk_f32 v206, v205, 0x42080000, v204
  v_cos_f32 v90, v206
  v_sin_f32 v102, v206
  v_fmamk_f32 v206, v205, 0x420c0000, v204
  v_cos_f32 v91, v206
  v_sin_f32 v103, v206
  s_mov_b32 s40, 0x3acccccd
  v_mov_b32 v15, 0x3727c5ac
  v_mov_b32 v190, 0
  v_mov_b32_e64 v191, 0
  s_mov_b32 s29, 0
  s_mov_b32 s36, 1
  s_mov_b32 s37, 0
  s_cmp_lt_u32 s3, 2
  s_cselect_b64 s[42:43], 1, 0
  s_cselect_b32 s7, 3200, 0
  s_cselect_b32 s52, 12, 8
  s_cselect_b32 s53, 0, 32
  s_lshl_b32 s7, s7, s3
  v_lshlrev_b32 v204, 4, v203
  v_mul_u32_u24 v13, 80, v202
  v_add3_u32 v13, v13, v204, s7
  v_and_b32_e64 v14, 7, v0
  v_mul_u32_u24 v14, 80, v14
  s_add_u32 s7, s7, 2560
  v_add3_u32 v14, v14, v204, s7
  s_mul_i32 s54, s52, s3
  s_lshl_b32 s54, s54, 2
  s_add_u32 s54, s54, s53
  s_sub_u32 s7, s52, 1
  v_min_u32 v205, s7, v202
  v_lshlrev_b32_e64 v205, 2, v205
  s_movk_i32 s7, 5120
  v_mad_u32_u24 v5, v203, s7, v205
  v_mul_u32_u24 v6, 160, v202
  s_add_u32 s7, s54, 9984
  v_add3_u32 v6, v6, v204, s7
  s_lshl_b32 s7, s52, 2
  v_cmp_gt_u32 vcc, s7, v204
  v_add_u32 v205, 15360, v1
  s_nop 0
  v_cndmask_b32 v6, v205, v6, vcc
  v_mul_u32_u24 v205, 205, v0
  v_lshrrev_b32_e64 v205, 11, v205
  v_mul_u32_u24 v205, 10080, v205
  v_add_u32 v9, v205, v7
  s_lshl_b32 s7, s3, 4
  s_add_u32 s7, s7, 256
  v_add_u32 v205, s7, v202
  v_lshlrev_b32 v8, 4, v205
  v_mul_u32_u24 v205, 205, v205
  v_lshrrev_b32_e64 v205, 11, v205
  v_mul_u32_u24 v205, 10080, v205
  v_add_u32 v10, v205, v8
  v_cmp_eq_u32 vcc, 0, v203
  v_mov_b32 v205, 1073741824
  s_nop 0
  v_cndmask_b32_e64 v10, v205, v10, vcc
  v_add_u32 v7, 9984, v7
  v_add_u32 v8, 9984, v8
  v_lshrrev_b32_e64 v2, 1, v1
  v_add_u32 v2, 896, v2
  v_add_u32 v206, -1, v203
  v_cmp_gt_u32 vcc, 2, v206
  s_nop 1
  v_cndmask_b32 v2, v205, v2, vcc
  v_and_b32 v205, 1, v203
  v_lshlrev_b32 v205, 7, v205
  v_and_b32_e64 v206, 3, v0
  v_lshl_add_u32 v11, v206, 5, v205
  v_add_u32 v11, 9600, v11
  v_bfe_u32 v206, v0, 2, 1
  v_lshl_add_u32 v205, v206, 6, v205
  v_bfe_u32 v206, v0, 3, 1
  v_lshl_add_u32 v205, v206, 5, v205
  v_bfe_u32 v206, v0, 5, 1
  v_lshl_add_u32 v205, v206, 2, v205
  s_lshl_b32 s7, s3, 3
  s_add_u32 s7, s7, 9600
  v_add_u32_e64 v12, s7, v205
  s_and_b32 s93, s5, 7
  s_mul_i32 s93, s93, 160
  s_lshl_b32 s94, s4, 7
  s_add_u32 s92, s94, s5
  s_mul_i32 s92, s92, 1280
  s_mul_i32 s31, s3, 40960
  s_add_u32 s31, s31, s92
  s_add_u32 s31, s31, 262144
  s_lshl_b32 s96, s95, 5
  s_add_u32 s96, s96, s94
  s_mul_i32 s32, s96, 1280
  s_add_u32 s32, s32, s93
  s_add_u32 s96, s54, 262144
  s_add_u32 s32, s32, s96
  s_add_u32 s33, s32, 20480
  s_lshl_b32 s96, s95, 8
  s_add_u32 s96, s96, s4
  s_mul_i32 s34, s96, 1280
  s_add_u32 s34, s34, s93
  s_add_u32 s34, s34, 4259840
  s_mov_b32 s35, 2949120
  s_lshl_b32 s7, s4, 2
  s_add_u32 s55, s7, s3
  s_lshl_b32 s55, s55, 5
  s_add_u32 s55, s55, s5
  s_lshl_b32 s55, s55, 2
  s_add_u32 s55, s55, 12288
  s_add_u32 s56, s95, s7
  s_lshl_b32 s56, s56, 7
  s_nop 0
  s_add_u32 s56, s56, 12288
  s_add_u32 s44, s34, 2621440
  s_and_b32 s7, s26, 127
  s_lshr_b32 s7, s7, 2
  s_sub_u32 s94, 0, s26
  s_and_b32 s94, s94, 127
  s_lshr_b32 s94, s94, 2
  s_bfe_u32 s95, s26, 0x10001
  s_cmp_eq_u32 s27, 1
  s_cselect_b32 s94, s7, s94
  s_cselect_b32 s96, 2, s95
  s_cselect_b32 s95, 3, s95
  s_lshl_b32 s96, s96, 5
  s_lshl_b32 s95, s95, 5
  s_add_u32 s7, s7, s96
  s_add_u32 s94, s94, s95
  s_mul_i32 s7, s7, 10240
  s_mul_i32 s94, s94, 10240
  v_mov_b32 v204, s7
  v_mov_b32 v205, s94
  v_cmp_le_u32 vcc, 2, v203
  s_lshl_b32 s95, s3, 8
  s_lshl_b32 s96, s3, 6
  v_cndmask_b32_e64 v204, v204, v205, vcc
  s_add_u32 s96, s96, 1024
  v_add_u32 v204, v204, v201
  v_lshlrev_b32 v205, 4, v202
  v_add3_u32 v3, v204, v205, s95
  v_lshlrev_b32_e64 v205, 2, v202
  v_add3_u32 v4, v204, v205, s96
  v_add_u32 v31, 25600, v1
  v_lshrrev_b32_e64 v252, 2, v1
  v_and_b32 v252, 127, v252
  s_lshl_b32 s7, s3, 2
  v_add_u32 v194, s7, v31
  ds_write_b32 v194, v224 offset:16384
  ds_write_b32 v194, v225 offset:18432
  ds_write_b32 v194, v226 offset:17408
  ds_write_b32 v194, v227 offset:19456
  ds_write_b32 v194, v228 offset:20480
  ds_write_b32 v194, v229 offset:22528
  ds_write_b32 v194, v230 offset:21504
  ds_write_b32 v194, v231 offset:23552
  s_waitcnt vmcnt(3) lgkmcnt(0)
  s_barrier
  ds_read_b128 v[56:59], v31 offset:0
  ds_read_b128 v[60:63], v31 offset:1024
  ds_read_b128 v[64:67], v31 offset:2048
  ds_read_b128 v[68:71], v31 offset:3072
  ds_read_b128 v[104:107], v31 offset:7168
  ds_read_b128 v[108:111], v31 offset:8192
  ds_read_b128 v[112:115], v31 offset:9216
  ds_read_b128 v[116:119], v31 offset:10240
  ds_read_b128 v[120:123], v31 offset:11264
  ds_read_b128 v[124:127], v31 offset:12288
  ds_read_b128 v[128:131], v31 offset:13312
  ds_read_b128 v[132:135], v31 offset:14336
  ds_read_b128 v[136:139], v31 offset:15360
  ds_read_b128 v[72:75], v31 offset:5120
  ds_read_b128 v[76:79], v31 offset:6144
  ds_read_b128 v[140:143], v31 offset:16384
  ds_read_b128 v[144:147], v31 offset:17408
  ds_read_b128 v[148:151], v31 offset:18432
  ds_read_b128 v[152:155], v31 offset:19456
  ds_read_b128 v[156:159], v31 offset:20480
  ds_read_b128 v[160:163], v31 offset:21504
  ds_read_b128 v[164:167], v31 offset:22528
  ds_read_b128 v[168:171], v31 offset:23552
  ds_read_b128 v[52:55], v31 offset:4096
  v_lshrrev_b32_e64 v21, 16, v18
  v_and_b32 v20, 0xffff, v18
  v_lshrrev_b32_e64 v19, 16, v17
  v_and_b32 v18, 0xffff, v17
  v_lshrrev_b32_e64 v17, 16, v16
  v_and_b32 v16, 0xffff, v16
  s_cmp_eq_u32 s3, 3
  s_cselect_b32 s7, 0x80008000, 0
  s_waitcnt lgkmcnt(11)
  v_xor_b32 v105, s7, v105
  v_xor_b32 v107, s7, v107
  v_xor_b32 v109, s7, v109
  v_xor_b32 v111, s7, v111
  v_xor_b32 v113, s7, v113
  v_xor_b32 v115, s7, v115
  v_xor_b32 v117, s7, v117
  v_xor_b32 v119, s7, v119
  v_xor_b32 v121, s7, v121
  v_xor_b32 v123, s7, v123
  v_xor_b32 v125, s7, v125
  v_xor_b32 v127, s7, v127
  v_xor_b32 v129, s7, v129
  v_xor_b32 v131, s7, v131
  v_xor_b32 v133, s7, v133
  v_xor_b32 v135, s7, v135
  v_xor_b32 v137, s7, v137
  v_xor_b32 v139, s7, v139
  s_waitcnt vmcnt(0)
  s_barrier
  ds_read_u16_d16_hi v32, v22 offset:0
  ds_read_u16_d16_hi v33, v22 offset:1280
  ds_read_u16_d16_hi v34, v22 offset:2560
  ds_read_u16_d16_hi v35, v22 offset:3840
  ds_read_u16_d16_hi v36, v23 offset:0
  ds_read_u16_d16_hi v37, v23 offset:1280
  ds_read_u16_d16_hi v38, v23 offset:2560
  ds_read_u16_d16_hi v39, v23 offset:3840
  ds_read_u16_d16_hi v40, v24 offset:0
  ds_read_u16_d16_hi v41, v24 offset:1280
  ds_read_u16_d16_hi v42, v24 offset:2560
  ds_read_u16_d16_hi v43, v24 offset:3840
  ds_read_u16_d16_hi v44, v25 offset:0
  ds_read_u16_d16_hi v45, v25 offset:1280
  ds_read_u16_d16_hi v46, v25 offset:2560
  ds_read_u16_d16_hi v47, v25 offset:3840
  ds_read_u16_d16_hi v48, v26 offset:0
  ds_read_u16_d16_hi v49, v26 offset:1280
  ds_read_u16_d16_hi v50, v26 offset:2560
  ds_read_u16_d16_hi v51, v26 offset:3840
  s_nop 0
  s_waitcnt lgkmcnt(0)
L_loop:
  v_pk_mul_f32 v[196:197], v[48:49], v[48:49]
  v_pk_mul_f32 v[198:199], v[50:51], v[50:51]
  v_pk_add_f32 v[192:193], v[48:49], v[32:33]
  v_pk_fma_f32 v[196:197], v[32:33], v[32:33], v[196:197]
  v_pk_add_f32 v[194:195], v[50:51], v[34:35]
  v_pk_fma_f32 v[198:199], v[34:35], v[34:35], v[198:199]
  v_pk_add_f32 v[192:193], v[192:193], v[36:37]
  v_pk_fma_f32 v[196:197], v[36:37], v[36:37], v[196:197]
  v_pk_add_f32 v[194:195], v[194:195], v[38:39]
  v_pk_fma_f32 v[198:199], v[38:39], v[38:39], v[198:199]
  v_pk_add_f32 v[192:193], v[192:193], v[40:41]
  v_pk_fma_f32 v[196:197], v[40:41], v[40:41], v[196:197]
  v_pk_add_f32 v[194:195], v[194:195], v[42:43]
  v_pk_fma_f32 v[198:199], v[42:43], v[42:43], v[198:199]
  v_pk_add_f32 v[192:193], v[192:193], v[44:45]
  v_pk_fma_f32 v[196:197], v[44:45], v[44:45], v[196:197]
  v_pk_add_f32 v[194:195], v[194:195], v[46:47]
  v_pk_fma_f32 v[198:199], v[46:47], v[46:47], v[198:199]
  v_permlane32_swap_b32 v192, v196
  v_permlane32_swap_b32 v193, v197
  v_permlane32_swap_b32 v194, v198
  v_permlane32_swap_b32 v195, v199
  v_pk_add_f32 v[192:193], v[192:193], v[196:197]
  v_pk_add_f32 v[194:195], v[194:195], v[198:199]
  s_nop 0
  s_nop 0
  v_add_f32_dpp v192, v192, v192 row_ror:8 row_mask:0xf bank_mask:0x3
  v_add_f32_dpp v192, v193, v193 row_ror:8 row_mask:0xf bank_mask:0xc
  v_add_f32_dpp v194, v194, v194 row_ror:8 row_mask:0xf bank_mask:0x3
  v_add_f32_dpp v194, v195, v195 row_ror:8 row_mask:0xf bank_mask:0xc
  v_add_f32_dpp v192, v192, v192 row_shl:4 row_mask:0xf bank_mask:0x5
  s_nop 0
  v_add_f32_dpp v192, v194, v194 row_shr:4 row_mask:0xf bank_mask:0xa
  s_nop 1
  v_add_f32_dpp v192, v192, v192 quad_perm:[1,0,3,2] row_mask:0xf bank_mask:0xf
  s_nop 1
  v_add_f32_dpp v192, v192, v192 quad_perm:[2,3,0,1] row_mask:0xf bank_mask:0xf
  ds_write_b32 v12, v192
  s_waitcnt lgkmcnt(0)
  s_barrier
  ds_read_b128 v[200:203], v11
  ds_read_b128 v[204:207], v11 offset:16
  s_waitcnt lgkmcnt(1)
  v_pk_add_f32 v[200:201], v[200:201], v[202:203]
  s_waitcnt lgkmcnt(0)
  v_pk_add_f32 v[204:205], v[204:205], v[206:207]
  v_pk_add_f32 v[200:201], v[200:201], v[204:205]
  v_mul_f32 v200, s40, v200
  v_fma_f32 v201, v201, s40, v15
  v_fma_f32 v201, -v200, v200, v201
  v_max_f32 v201, v201, v15
  v_rsq_f32_e64 v201, v201
  s_nop 0
  v_mul_f32 v200, -v200, v201
  v_mov_b32_dpp v208, v201 quad_perm:[0,0,0,0] row_mask:0xf bank_mask:0xf
  v_mov_b32_dpp v209, v201 quad_perm:[1,1,1,1] row_mask:0xf bank_mask:0xf
  v_mov_b32_dpp v210, v201 quad_perm:[2,2,2,2] row_mask:0xf bank_mask:0xf
  v_mov_b32_dpp v211, v201 quad_perm:[3,3,3,3] row_mask:0xf bank_mask:0xf
  v_mov_b32_dpp v212, v200 quad_perm:[0,0,0,0] row_mask:0xf bank_mask:0xf
  v_mov_b32_dpp v213, v200 quad_perm:[1,1,1,1] row_mask:0xf bank_mask:0xf
  v_mov_b32_dpp v214, v200 quad_perm:[2,2,2,2] row_mask:0xf bank_mask:0xf
  v_mov_b32_dpp v215, v200 quad_perm:[3,3,3,3] row_mask:0xf bank_mask:0xf
  v_pk_fma_f32 v[216:217], v[32:33], v[208:209], v[212:213]
  v_pk_fma_f32 v[218:219], v[34:35], v[210:211], v[214:215]
  v_pk_fma_f32 v[220:221], v[36:37], v[208:209], v[212:213]
  v_pk_fma_f32 v[222:223], v[38:39], v[210:211], v[214:215]
  v_pk_fma_f32 v[224:225], v[40:41], v[208:209], v[212:213]
  v_pk_fma_f32 v[226:227], v[42:43], v[210:211], v[214:215]
  v_pk_fma_f32 v[228:229], v[44:45], v[208:209], v[212:213]
  v_pk_fma_f32 v[230:231], v[46:47], v[210:211], v[214:215]
  v_pk_fma_f32 v[232:233], v[48:49], v[208:209], v[212:213]
  v_pk_fma_f32 v[234:235], v[50:51], v[210:211], v[214:215]
  v_cvt_pk_f16_f32 v180, v216, v217
  v_cvt_pk_f16_f32 v181, v218, v219
  v_cvt_pk_f16_f32 v182, v220, v221
  v_cvt_pk_f16_f32 v183, v222, v223
  v_cvt_pk_f16_f32 v184, v224, v225
  v_cvt_pk_f16_f32 v185, v226, v227
  v_mfma_f32_16x16x32_f16 v[192:195], v[56:59], v[180:183], 0
  v_cvt_pk_f16_f32 v186, v228, v229
  v_cvt_pk_f16_f32 v187, v230, v231
  v_mfma_f32_16x16x32_f16 v[200:203], v[60:63], v[180:183], 0
  v_cvt_pk_f16_f32 v188, v232, v233
  v_cvt_pk_f16_f32 v189, v234, v235
  v_mfma_f32_16x16x32_f16 v[196:199], v[56:59], v[184:187], 0
  v_mfma_f32_16x16x32_f16 v[200:203], v[64:67], v[184:187], v[200:203]
  s_cmp_lg_u32 s41, 0
  v_mfma_f32_16x16x32_f16 v[204:207], v[68:71], v[188:191], 0
  v_cvt_pk_f16_f32 v236, v192, v193
  s_cbranch_scc0 L_fix
L_nofix:
  v_cvt_pk_f16_f32 v237, v194, v195
  ds_write_b32 v16, v236
  ds_write_b32 v16, v237 offset:3200
  v_cvt_pk_f16_f32 v238, v196, v197
  v_cvt_pk_f16_f32 v239, v198, v199
  v_cvt_pk_f16_f32 v240, v200, v201
  v_cvt_pk_f16_f32 v241, v202, v203
  ds_write_b32 v17, v238
  ds_write_b32 v17, v239 offset:3200
  v_cvt_pk_f16_f32 v242, v204, v205
  v_cvt_pk_f16_f32 v243, v206, v207
  ds_write_b32 v18, v240
  ds_write_b32 v19, v241
  ds_write_b32 v20, v242
  ds_write_b32 v21, v243
  s_cmp_eq_u32 s29, 0
  s_nop 0
  s_waitcnt lgkmcnt(0)
  s_barrier
  ds_read_b128 v[192:195], v13
  ds_read_b128 v[196:199], v13 offset:1280
  ds_read_b128 v[200:203], v14
  s_cbranch_scc1 L_l0b
L_l0b_ret:
  s_waitcnt lgkmcnt(2)
  v_mfma_f32_16x16x32_f16 v[204:207], v[192:195], v[72:75], 0
  v_mfma_f32_16x16x32_f16 v[216:219], v[192:195], v[76:79], 0
  s_waitcnt lgkmcnt(1)
  v_mfma_f32_16x16x32_f16 v[208:211], v[196:199], v[72:75], 0
  v_mfma_f32_16x16x32_f16 v[220:223], v[196:199], v[76:79], 0
  s_waitcnt lgkmcnt(0)
  v_mfma_f32_16x16x32_f16 v[212:215], v[200:203], v[72:75], 0
  v_mfma_f32_16x16x32_f16 v[224:227], v[200:203], v[76:79], 0
  s_nop 0
  s_nop 0
  v_pk_mul_f32 v[228:229], v[204:205], v[80:81]
  v_pk_mul_f32 v[230:231], v[206:207], v[82:83]
  v_pk_fma_f32 v[228:229], v[216:217], v[92:93], v[228:229]
  v_pk_fma_f32 v[230:231], v[218:219], v[94:95], v[230:231]
  v_pk_mul_f32 v[216:217], v[216:217], v[80:81]
  v_pk_mul_f32 v[218:219], v[218:219], v[82:83]
  v_pk_fma_f32 v[216:217], v[204:205], v[92:93], v[216:217] neg_lo:[1,0,0] neg_hi:[1,0,0]
  v_pk_fma_f32 v[218:219], v[206:207], v[94:95], v[218:219] neg_lo:[1,0,0] neg_hi:[1,0,0]
  v_pk_mul_f32 v[232:233], v[208:209], v[84:85]
  v_pk_mul_f32 v[234:235], v[210:211], v[86:87]
  v_pk_fma_f32 v[232:233], v[220:221], v[96:97], v[232:233]
  v_pk_fma_f32 v[234:235], v[222:223], v[98:99], v[234:235]
  v_pk_mul_f32 v[220:221], v[220:221], v[84:85]
  v_pk_mul_f32 v[222:223], v[222:223], v[86:87]
  v_pk_fma_f32 v[220:221], v[208:209], v[96:97], v[220:221] neg_lo:[1,0,0] neg_hi:[1,0,0]
  v_pk_fma_f32 v[222:223], v[210:211], v[98:99], v[222:223] neg_lo:[1,0,0] neg_hi:[1,0,0]
  v_pk_mul_f32 v[236:237], v[212:213], v[88:89]
  v_pk_mul_f32 v[238:239], v[214:215], v[90:91]
  v_pk_fma_f32 v[236:237], v[224:225], v[100:101], v[236:237]
  v_pk_fma_f32 v[238:239], v[226:227], v[102:103], v[238:239]
  v_pk_mul_f32 v[224:225], v[224:225], v[88:89]
  v_pk_mul_f32 v[226:227], v[226:227], v[90:91]
  v_pk_fma_f32 v[224:225], v[212:213], v[100:101], v[224:225] neg_lo:[1,0,0] neg_hi:[1,0,0]
  v_pk_fma_f32 v[226:227], v[214:215], v[102:103], v[226:227] neg_lo:[1,0,0] neg_hi:[1,0,0]
  v_cvt_pk_f16_f32 v204, v228, v216
  v_cvt_pk_f16_f32 v205, v229, v217
  v_cvt_pk_f16_f32 v206, v230, v218
  v_cvt_pk_f16_f32 v207, v231, v219
  v_cvt_pk_f16_f32 v208, v232, v220
  v_cvt_pk_f16_f32 v209, v233, v221
  v_mfma_f32_16x16x32_f16 v[200:203], v[128:131], v[204:207], 0
  v_cvt_pk_f16_f32 v210, v234, v222
  v_cvt_pk_f16_f32 v211, v235, v223
  v_mfma_f32_16x16x32_f16 v[192:195], v[104:107], v[204:207], 0
  v_cvt_pk_f16_f32 v212, v236, v224
  v_cvt_pk_f16_f32 v213, v237, v225
  v_mfma_f32_16x16x32_f16 v[196:199], v[116:119], v[204:207], 0
  v_cvt_pk_f16_f32 v214, v238, v226
  v_cvt_pk_f16_f32 v215, v239, v227
  v_mfma_f32_16x16x32_f16 v[200:203], v[132:135], v[208:211], v[200:203]
  v_mfma_f32_16x16x32_f16 v[192:195], v[108:111], v[208:211], v[192:195]
  v_mfma_f32_16x16x32_f16 v[200:203], v[136:139], v[212:215], v[200:203]
  v_mfma_f32_16x16x32_f16 v[192:195], v[112:115], v[212:215], v[192:195]
  v_mfma_f32_16x16x32_f16 v[196:199], v[120:123], v[208:211], v[196:199]
  v_mfma_f32_16x16x32_f16 v[196:199], v[124:127], v[212:215], v[196:199]
  s_mov_b32 s38, 50000
  s_add_u32 s35, s35, 1310720
  s_cmp_lg_u32 s30, 0
  s_nop 1
  v_cvt_pk_f16_f32 v244, v200, v201
  v_cvt_pk_f16_f32 v245, v202, v203
  v_and_or_b32 v245, v245, -2, s36
  v_cvt_pk_f16_f32 v240, v192, v193
  v_cvt_pk_f16_f32 v241, v194, v195
  v_cndmask_b32 v240, v240, v244, s[42:43]
  v_and_or_b32 v244, v244, -2, s36
  v_and_or_b32 v241, v241, -2, s36
  v_and_or_b32 v240, v240, -2, s36
  v_cvt_pk_f16_f32 v242, v196, v197
  v_cvt_pk_f16_f32 v243, v198, v199
  v_and_or_b32 v242, v242, -2, s36
  v_and_or_b32 v243, v243, -2, s36
  s_cbranch_scc1 L_st_slow
  s_nop 0
  buffer_store_dwordx2 v[244:245], v2, s[16:19], s31 offen
  buffer_store_dwordx4 v[240:243], v1, s[16:19], s31 offen
L_cphase:
  s_xor_b32 s31, s31, 2097152
  s_cmp_eq_u32 s29, 0
  s_cbranch_scc1 L_l0c
L_l0c_ret:
  s_nop 0
  s_waitcnt vmcnt(0)
L_poll1:
  buffer_load_dword v204, v5, s[16:19], s32 offen offset:0 sc1
  buffer_load_dword v205, v5, s[16:19], s32 offen offset:1280 sc1
  buffer_load_dword v206, v5, s[16:19], s32 offen offset:2560 sc1
  buffer_load_dword v207, v5, s[16:19], s32 offen offset:3840 sc1
  buffer_load_dword v208, v5, s[16:19], s33 offen offset:0 sc1
  buffer_load_dword v209, v5, s[16:19], s33 offen offset:1280 sc1
  buffer_load_dword v210, v5, s[16:19], s33 offen offset:2560 sc1
  buffer_load_dword v211, v5, s[16:19], s33 offen offset:3840 sc1
  s_sub_u32 s38, s38, 1
  s_cbranch_scc1 L_poll1_to
  s_nop 0
  s_waitcnt vmcnt(4)
  v_mfma_f32_16x16x32_f16 v[212:215], v[204:207], v[140:143], 0
  v_bitop3_b32 v228, v204, v205, s37 bitop3:0x42
  v_mfma_f32_16x16x32_f16 v[216:219], v[204:207], v[148:151], 0
  v_bitop3_b32 v229, v206, v207, s37 bitop3:0x42
  v_mfma_f32_16x16x32_f16 v[220:223], v[204:207], v[156:159], 0
  v_bitop3_b32 v228, v228, v229, 1 bitop3:0x80
  v_mfma_f32_16x16x32_f16 v[224:227], v[204:207], v[164:167], 0
  s_nop 0
  s_waitcnt vmcnt(0)
  v_mfma_f32_16x16x32_f16 v[212:215], v[208:211], v[144:147], v[212:215]
  v_bitop3_b32 v230, v208, v209, s37 bitop3:0x42
  v_mfma_f32_16x16x32_f16 v[216:219], v[208:211], v[152:155], v[216:219]
  v_bitop3_b32 v231, v210, v211, s37 bitop3:0x42
  v_mfma_f32_16x16x32_f16 v[220:223], v[208:211], v[160:163], v[220:223]
  v_bitop3_b32 v228, v228, v230, v231 bitop3:0x80
  v_cmp_eq_u32_e64 vcc, 0, v228
  v_mfma_f32_16x16x32_f16 v[224:227], v[208:211], v[168:171], v[224:227]
  s_cbranch_vccnz L_poll1_re
L_poll1_done:
  s_nop 1
  v_cvt_pk_f16_f32 v228, v212, v216
  v_cvt_pk_f16_f32 v229, v213, v217
  v_cvt_pk_f16_f32 v230, v214, v218
  v_cvt_pk_f16_f32 v231, v215, v219
  v_or_b32 v228, 1, v228
  v_or_b32 v229, 1, v229
  v_or_b32 v230, 1, v230
  v_or_b32 v231, 1, v231
  ds_write_b128 v6, v[228:231] offset:0
  v_cvt_pk_f16_f32 v232, v220, v224
  v_cvt_pk_f16_f32 v233, v221, v225
  v_cvt_pk_f16_f32 v234, v222, v226
  v_cvt_pk_f16_f32 v235, v223, v227
  v_or_b32 v232, 1, v232
  v_or_b32 v233, 1, v233
  v_or_b32 v234, 1, v234
  v_or_b32 v235, 1, v235
  ds_write_b128 v6, v[232:235] offset:2560
  s_waitcnt lgkmcnt(0)
  s_barrier
  ds_read_b128 v[192:195], v7
  ds_read_b128 v[196:199], v8
  s_waitcnt lgkmcnt(1)
  buffer_store_dwordx4 v[192:195], v9, s[16:19], s34 offen sc1
  s_waitcnt lgkmcnt(0)
  buffer_store_dwordx4 v[196:199], v10, s[16:19], s34 offen sc1
  buffer_store_dwordx4 v[248:251], v9, s[16:19], s44 offen sc1
  buffer_store_dwordx4 v[248:251], v10, s[16:19], s44 offen sc1
  s_mov_b32 s44, 1073741824
  s_mov_b32 s38, 50000
  s_add_u32 s29, s29, 1
  s_add_u32 s34, s34, 1310720
  s_xor_b32 s32, s32, 2097152
  s_xor_b32 s33, s33, 2097152
  s_cmp_ge_u32 s29, 2
  s_cselect_b32 s36, 0, 1
  s_cselect_b32 s37, -1, 0
  s_cmp_eq_u32 s29, 1
  s_cbranch_scc1 L_l0d
L_l0d_ret:
  s_waitcnt vmcnt(2)
L_poll2:
  buffer_load_dword v216, v4, s[16:19], s35 offen offset:0 sc1
  buffer_load_dword v217, v4, s[16:19], s35 offen offset:1280 sc1
  buffer_load_dword v218, v4, s[16:19], s35 offen offset:2560 sc1
  buffer_load_dword v219, v4, s[16:19], s35 offen offset:3840 sc1
  buffer_load_dwordx4 v[200:203], v3, s[16:19], s35 offen offset:0 sc1
  buffer_load_dwordx4 v[204:207], v3, s[16:19], s35 offen offset:1280 sc1
  buffer_load_dwordx4 v[208:211], v3, s[16:19], s35 offen offset:2560 sc1
  buffer_load_dwordx4 v[212:215], v3, s[16:19], s35 offen offset:3840 sc1
  s_sub_u32 s38, s38, 1
  s_cbranch_scc1 L_poll2_to
  s_nop 0
  s_waitcnt vmcnt(3)
  v_bitop3_b32 v220, v216, v217, 1 bitop3:0x80
  v_bitop3_b32 v221, v218, v219, v200 bitop3:0x80
  v_bitop3_b32 v220, v220, v201, v202 bitop3:0x80
  v_bitop3_b32 v220, v220, v221, v203 bitop3:0x80
  v_and_b32 v200, v27, v200
  s_waitcnt vmcnt(2)
  v_bitop3_b32 v220, v220, v204, v205 bitop3:0x80
  v_bitop3_b32 v220, v220, v206, v207 bitop3:0x80
  v_and_b32_e64 v204, v27, v204
  v_swap_b32 v201, v204
  s_waitcnt vmcnt(1)
  v_bitop3_b32 v220, v220, v208, v209 bitop3:0x80
  v_bitop3_b32 v220, v220, v210, v211 bitop3:0x80
  v_and_b32 v208, v27, v208
  v_swap_b32 v202, v208
  v_swap_b32 v206, v209
  s_waitcnt vmcnt(0)
  v_bitop3_b32 v220, v220, v212, v213 bitop3:0x80
  v_bitop3_b32 v220, v220, v214, v215 bitop3:0x80
  v_and_b32 v212, v27, v212
  v_cmp_eq_u32 vcc, 0, v220
  v_swap_b32 v203, v212
  s_cbranch_vccnz L_poll2_re
L_poll2_done:
  v_mfma_f32_16x16x32_f16 v[48:51], v[52:55], v[216:219], v[48:51]
  v_swap_b32 v207, v213
  v_mfma_f32_16x16x32_f16 v[32:35], v[52:55], v[200:203], v[32:35]
  v_swap_b32 v211, v214
  v_mfma_f32_16x16x32_f16 v[36:39], v[52:55], v[204:207], v[36:39]
  s_cmp_lt_u32 s29, 4
  v_mfma_f32_16x16x32_f16 v[40:43], v[52:55], v[208:211], v[40:43]
  v_mfma_f32_16x16x32_f16 v[44:47], v[52:55], v[212:215], v[44:47]
  s_cbranch_scc1 L_loop
  v_cvt_pk_bf16_f32 v200, v48, v49
  v_cvt_pk_bf16_f32 v201, v50, v51
  ds_write_b16 v26, v200 offset:0
  ds_write_b16_d16_hi v26, v200 offset:1280
  ds_write_b16 v26, v201 offset:2560
  ds_write_b16_d16_hi v26, v201 offset:3840
  v_cvt_pk_bf16_f32 v192, v32, v33
  v_cvt_pk_bf16_f32 v193, v34, v35
  ds_write_b16 v22, v192 offset:0
  ds_write_b16_d16_hi v22, v192 offset:1280
  ds_write_b16 v22, v193 offset:2560
  ds_write_b16_d16_hi v22, v193 offset:3840
  v_cvt_pk_bf16_f32 v194, v36, v37
  v_cvt_pk_bf16_f32 v195, v38, v39
  ds_write_b16 v23, v194 offset:0
  ds_write_b16_d16_hi v23, v194 offset:1280
  ds_write_b16 v23, v195 offset:2560
  ds_write_b16_d16_hi v23, v195 offset:3840
  v_cvt_pk_bf16_f32 v196, v40, v41
  v_cvt_pk_bf16_f32 v197, v42, v43
  ds_write_b16 v24, v196 offset:0
  ds_write_b16_d16_hi v24, v196 offset:1280
  ds_write_b16 v24, v197 offset:2560
  ds_write_b16_d16_hi v24, v197 offset:3840
  v_cvt_pk_bf16_f32 v198, v44, v45
  v_cvt_pk_bf16_f32 v199, v46, v47
  ds_write_b16 v25, v198 offset:0
  ds_write_b16_d16_hi v25, v198 offset:1280
  ds_write_b16 v25, v199 offset:2560
  ds_write_b16_d16_hi v25, v199 offset:3840
  s_waitcnt lgkmcnt(0)
  s_barrier
  ds_read_b128 v[204:207], v7 offset:5376
  ds_read_b128 v[208:211], v7 offset:9472
  ds_read_b128 v[212:215], v7 offset:13568
  s_waitcnt lgkmcnt(2)
  buffer_store_dwordx4 v[204:207], v28, s[12:15], 0 offen nt
  s_waitcnt lgkmcnt(1)
  buffer_store_dwordx4 v[208:211], v29, s[12:15], 0 offen nt
  s_waitcnt lgkmcnt(0)
  buffer_store_dwordx4 v[212:215], v30, s[12:15], 0 offen nt
L_end:
  s_endpgm
L_fix:
  s_nop 0
  s_nop 6
  v_mfma_f32_16x16x32_f16 v[216:219], v[172:175], v[180:183], 0
  v_mfma_f32_16x16x32_f16 v[220:223], v[176:179], v[180:183], 0
  s_mov_b32 exec_lo, 0x00010001
  s_mov_b32 exec_hi, 0x00010001
  s_nop 0
  s_nop 3
  v_pk_add_f32 v[192:193], v[192:193], v[216:217]
  v_pk_add_f32 v[194:195], v[194:195], v[218:219]
  v_pk_add_f32 v[200:201], v[200:201], v[220:221]
  v_pk_add_f32 v[202:203], v[202:203], v[222:223]
  s_mov_b64 exec, -1
  v_cvt_pk_f16_f32 v236, v192, v193
  s_branch L_nofix
L_l0b:
  v_mov_b32 v246, 9856
  ds_read_b32 v247, v246 offset:8
  ds_read_b32 v253, v252 offset:15104
  ds_read_b32 v246, v246
  s_waitcnt lgkmcnt(0)
  v_readfirstlane_b32 s30, v246
  s_branch L_l0b_ret
L_l0c:
  s_cmp_lg_u32 s30, 0
  s_mov_b64 exec, 1
  s_waitcnt vmcnt(0)
  s_cbranch_scc1 L_l0c_slow
  buffer_store_dword v247, off, s[16:19], s55
L_l0c_p:
  s_mov_b64 exec, -1
L_l0c_poll:
  buffer_load_dword v246, v252, s[16:19], s56 offen sc1
  s_sub_u32 s38, s38, 1
  s_cbranch_scc1 L_poll1_to
  s_waitcnt vmcnt(0)
  v_cmp_ne_u32 vcc, v246, v253
  s_nop 0
  s_cbranch_vccz L_poll1
  s_sleep 1
  s_branch L_l0c_poll
L_l0c_slow:
  buffer_store_dword v247, off, s[16:19], s55 sc1
  s_branch L_l0c_p
L_l0d:
  v_mov_b32 v242, 9860
L_l0d_spin:
  ds_read_b32 v243, v242
  s_waitcnt lgkmcnt(0)
  v_cmp_eq_u32 vcc, 0, v243
  s_nop 0
  s_cbranch_vccnz L_l0d_spin
  s_branch L_l0d_ret
L_st_slow:
  buffer_store_dwordx4 v[240:243], v1, s[16:19], s31 offen sc1
  buffer_store_dwordx2 v[244:245], v2, s[16:19], s31 offen sc1
  s_waitcnt vmcnt(0)
  s_branch L_cphase
L_poll1_re:
  s_sleep 1
  s_branch L_poll1
L_poll2_re:
  s_sleep 1
  s_branch L_poll2
L_poll1_to:
  s_waitcnt vmcnt(0)
  s_branch L_poll1_done
L_poll2_to:
  s_waitcnt vmcnt(0)
  s_branch L_poll2_done
L_hk2:
  s_setprio 0
  s_add_u32 s98, s94, 2097152
  s_getreg_b32 s6, hwreg(HW_REG_XCC_ID, 0, 4)
  s_mov_b32 s92, 8192
  s_mov_b32 s93, 9216
  s_mov_b32 s95, 10240
  s_mov_b32 s96, 11264
  s_mov_b32 s50, 0x9e3779b1
  s_mov_b32 s51, 0x7f4a7c15
  v_mov_b32 v9, 9856
  ds_write_b32 v9, v4 offset:4
  s_lshr_b32 s52, s5, 3
  s_lshl_b32 s52, s52, 8
  s_add_u32 s52, s52, s4
  s_mul_i32 s52, s52, 1280
  s_and_b32 s53, s5, 7
  s_mul_i32 s53, s53, 160
  s_add_u32 s52, s52, s53
  s_add_u32 s52, s52, 4259840
  s_movk_i32 s53, 10080
  s_lshl_b32 s54, s4, 9
  s_add_u32 s54, s54, 4096
  v_add_u32 v30, 0, v1
  v_mul_u32_u24 v29, 205, v30
  v_lshrrev_b32_e64 v29, 15, v29
  v_mad_u32_u24 v30, v29, s53, v30
  v_add_u32 v31, 1024, v1
  v_mul_u32_u24 v29, 205, v31
  v_lshrrev_b32_e64 v29, 15, v29
  v_mad_u32_u24 v31, v29, s53, v31
  v_add_u32 v32, 2048, v1
  v_mul_u32_u24 v29, 205, v32
  v_lshrrev_b32_e64 v29, 15, v29
  v_mad_u32_u24 v32, v29, s53, v32
  v_add_u32 v33, 3072, v1
  v_mul_u32_u24 v29, 205, v33
  v_lshrrev_b32_e64 v29, 15, v29
  v_mad_u32_u24 v33, v29, s53, v33
  v_add_u32 v34, 4096, v1
  v_mul_u32_u24 v29, 205, v34
  v_lshrrev_b32_e64 v29, 15, v29
  v_mad_u32_u24 v34, v29, s53, v34
  s_waitcnt vmcnt(2) lgkmcnt(0)
  v_mul_lo_u32 v13, v24, s50
  v_add_u32 v13, s51, v13
  v_and_or_b32 v13, v13, -16, s6
  s_mov_b64 exec, 1
  s_nop 0
  buffer_store_dword v13, v26, s[16:19], s97 offen offset:4 sc1
  v_mov_b32 v9, 9864
  ds_write_b32 v9, v13
  s_mov_b64 exec, -1
  v_lshlrev_b32 v27, 17, v1
  s_lshl_b32 s7, s2, 7
  s_mov_b64 exec, 3
  buffer_load_dword v28, v27, s[12:15], s7 offen
  s_mov_b64 exec, -1
  s_barrier
  s_barrier
  s_mov_b32 exec_hi, 0
  buffer_load_dwordx3 v[8:10], v1, s[16:19], s54 offen sc1
  s_mov_b64 exec, -1
  s_nop 0
  buffer_store_dwordx4 v[4:7], v30, s[16:19], s52 offen sc1
  buffer_store_dwordx4 v[4:7], v31, s[16:19], s52 offen sc1
  buffer_store_dwordx4 v[4:7], v32, s[16:19], s52 offen sc1
  buffer_store_dwordx4 v[4:7], v33, s[16:19], s52 offen sc1
  buffer_store_dwordx4 v[4:7], v34, s[16:19], s52 offen sc1
  buffer_store_dwordx4 v[4:7], v1, s[16:19], s44 offen offset:0 sc1
  buffer_store_dwordx4 v[4:7], v1, s[16:19], s44 offen offset:1024 sc1
  buffer_store_dwordx4 v[4:7], v1, s[16:19], s44 offen offset:2048 sc1
  buffer_store_dwordx4 v[4:7], v1, s[16:19], s44 offen offset:3072 sc1
  s_add_u32 s7, s44, 4096
  buffer_store_dwordx4 v[4:7], v1, s[16:19], s7 offen sc1
  s_add_u32 s44, s44, 1310720
  buffer_store_dwordx4 v[4:7], v1, s[16:19], s98 offen offset:0
  buffer_store_dwordx4 v[4:7], v1, s[16:19], s98 offen offset:1024
  buffer_store_dwordx4 v[4:7], v1, s[16:19], s98 offen offset:2048
  buffer_store_dwordx4 v[4:7], v1, s[16:19], s98 offen offset:3072
  s_add_u32 s7, s98, 4096
  buffer_store_dwordx4 v[4:7], v1, s[16:19], s7 offen
  s_barrier
  s_mov_b32 exec_hi, 0
  s_waitcnt vmcnt(15)
  s_mov_b32 exec_hi, 0
  s_mov_b32 s38, 50000
  s_branch L_hs_chk
L_hs:
  s_sleep 1
  buffer_load_dwordx3 v[8:10], v1, s[16:19], s54 offen sc1
  s_sub_u32 s38, s38, 1
  s_cbranch_scc1 L_hs_to
  s_waitcnt vmcnt(0)
L_hs_chk:
  v_mul_lo_u32 v8, v8, s50
  v_add_u32 v8, s51, v8
  v_xor_b32 v8, v8, v9
  v_cmp_lt_u32 vcc, 15, v8
  s_nop 0
  s_cbranch_vccnz L_hs
  s_branch L_hs_done
L_hs_to:
  s_waitcnt vmcnt(0)
L_hs_done:
  v_lshrrev_b32_e64 v11, 2, v1
  ds_write_b32 v11, v9 offset:15104
  v_and_b32 v11, 15, v9
  v_cmp_ne_u32 vcc, s6, v11
  s_mov_b64 exec, -1
  s_cmp_lg_u32 vcc_lo, 0
  s_cselect_b32 s30, 1, 0
  v_mov_b32 v8, s30
  v_mov_b32 v9, 9856
  ds_write_b32 v9, v8
  s_cmp_eq_u32 s30, 0
  s_cbranch_scc1 L_hk_go
  buffer_store_dwordx4 v[4:7], v1, s[16:19], s98 offen offset:0 sc1
  buffer_store_dwordx4 v[4:7], v1, s[16:19], s98 offen offset:1024 sc1
  buffer_store_dwordx4 v[4:7], v1, s[16:19], s98 offen offset:2048 sc1
  buffer_store_dwordx4 v[4:7], v1, s[16:19], s98 offen offset:3072 sc1
  s_add_u32 s7, s98, 4096
  buffer_store_dwordx4 v[4:7], v1, s[16:19], s7 offen sc1
L_hk_go:
  s_waitcnt lgkmcnt(0)
  s_barrier
  s_mov_b64 exec, 2
  s_waitcnt vmcnt(0)
  buffer_store_dword v13, v26, s[16:19], s97 offen offset:4 sc1
  s_mov_b64 exec, -1
  s_barrier
  s_mov_b32 s38, 50000
L_hs2:
  buffer_load_dwordx2 v[16:17], v1, s[16:19], s92 offen sc1
  buffer_load_dwordx2 v[18:19], v1, s[16:19], s93 offen sc1
  buffer_load_dwordx2 v[20:21], v1, s[16:19], s95 offen sc1
  buffer_load_dwordx2 v[22:23], v1, s[16:19], s96 offen sc1
  s_sub_u32 s38, s38, 1
  s_cbranch_scc1 L_hs2_done
L_hs2_w:
  s_waitcnt vmcnt(0)
  v_mul_lo_u32 v16, v16, s50
  v_add_u32 v16, s51, v16
  v_mul_lo_u32 v18, v18, s50
  v_add_u32_e64 v18, s51, v18
  v_mul_lo_u32 v20, v20, s50
  v_add_u32_e64 v20, s51, v20
  v_mul_lo_u32 v22, v22, s50
  v_add_u32 v22, s51, v22
  v_xor_b32 v16, v16, v17
  v_xor_b32 v18, v18, v19
  v_xor_b32 v20, v20, v21
  v_xor_b32_e64 v22, v22, v23
  v_or3_b32 v8, v16, v18, v20
  v_or_b32 v8, v8, v22
  v_cmp_lt_u32 vcc, 15, v8
  s_nop 0
  s_cbranch_vccz L_hs2_done
  s_sleep 1
  s_branch L_hs2
L_hs2_done:
  s_waitcnt vmcnt(0)
  v_mov_b32 v8, 1
  v_mov_b32 v9, 9860
  ds_write_b32 v9, v8
  s_barrier
  v_lshlrev_b32 v20, 3, v1
  v_min_u32 v20, 4992, v20
  buffer_load_dword v35, v20, s[16:19], s98 offen
  s_add_u32 s44, s44, 1310720
  buffer_store_dwordx4 v[4:7], v1, s[16:19], s44 offen offset:0 sc1
  buffer_store_dwordx4 v[4:7], v1, s[16:19], s44 offen offset:1024 sc1
  buffer_store_dwordx4 v[4:7], v1, s[16:19], s44 offen offset:2048 sc1
  buffer_store_dwordx4 v[4:7], v1, s[16:19], s44 offen offset:3072 sc1
  s_add_u32 s7, s44, 4096
  buffer_store_dwordx4 v[4:7], v1, s[16:19], s7 offen sc1
  v_add_u32 v24, 1, v24
  s_mov_b64 exec, 3
  s_barrier
  s_waitcnt vmcnt(0)
  s_barrier
  s_barrier
  buffer_store_dword v24, v26, s[16:19], s97 offen sc1
  s_barrier
  s_barrier
  s_cmp_lg_u32 s5, 0
  s_cbranch_scc1 L_end
  s_barrier
  buffer_wbl2 sc1
  s_barrier
  s_barrier
  s_waitcnt vmcnt(0)
  s_endpgm
L_codeend:
.section .rodata,"a"
.p2align 6
.amdhsa_kernel interleave_layers__spectral_fnet__spectral_fnet__prompt_kernel
  .amdhsa_next_free_vgpr 256
  .amdhsa_next_free_sgpr 102
  .amdhsa_accum_offset 256
  .amdhsa_group_segment_fixed_size 0
  .amdhsa_kernarg_size 104
  .amdhsa_user_sgpr_count 2
  .amdhsa_user_sgpr_kernarg_segment_ptr 1
  .amdhsa_system_sgpr_workgroup_id_x 1
.end_amdhsa_kernel
.p2align 10
tbl:
.long 0x3c00,0xbc00,0x0,0x0,0xbc000000,0x3c000000,0x0,0x0
.long 0x3c003c00,0x3c003c00,0x0,0x0,0x0,0x0,0x0,0x0
.long 0x0,0x0,0x3c00,0xbc00,0x0,0x0,0xbc000000,0x3c000000
.long 0x0,0x0,0x3c003c00,0x3c003c00,0x0,0x0,0x0,0x0
.long 0x0,0x0,0x0,0x0,0x0,0x0,0x0,0x0
.long 0x0,0x0,0x0,0x0,0x0,0x0,0x0,0x0
.long 0x0,0x0,0x0,0x0,0x0,0x0,0x0,0x0
.long 0x0,0x0,0x0,0x0,0x0,0x0,0x0,0x0
.long 0xbc000000,0x3c000000,0x0,0x0,0x3c00,0xbc00,0x0,0x0
.long 0x3c003c00,0x3c003c00,0x0,0x0,0x0,0x0,0x0,0x0
.long 0x0,0x0,0xbc000000,0x3c000000,0x0,0x0,0x3c00,0xbc00
.long 0x0,0x0,0x3c003c00,0x3c003c00,0x0,0x0,0x0,0x0
.long 0x0,0x0,0x0,0x0,0x0,0x0,0x0,0x0
.long 0x0,0x0,0x0,0x0,0x0,0x0,0x0,0x0
.long 0x0,0x0,0x0,0x0,0x0,0x0,0x0,0x0
.long 0x0,0x0,0x0,0x0,0x0,0x0,0x0,0x0
.long 0x0,0x0,0x0,0x0,0x0,0x0,0x0,0x0
.long 0x0,0x0,0x0,0x0,0x0,0x0,0x0,0x0
.long 0x0,0x0,0x0,0x0,0x0,0x0,0x0,0x0
.long 0x0,0x0,0x0,0x0,0x0,0x0,0x0,0x0
.long 0x3c00,0xbc00,0x0,0x0,0xbc000000,0x3c000000,0x0,0x0
.long 0x3c003c00,0x3c003c00,0x0,0x0,0x0,0x0,0x0,0x0
.long 0x0,0x0,0x3c00,0xbc00,0x0,0x0,0xbc000000,0x3c000000
.long 0x0,0x0,0x3c003c00,0x3c003c00,0x0,0x0,0x0,0x0
.long 0x0,0x0,0x0,0x0,0x0,0x0,0x0,0x0
.long 0x0,0x0,0x0,0x0,0x0,0x0,0x0,0x0
.long 0x0,0x0,0x0,0x0,0x0,0x0,0x0,0x0
.long 0x0,0x0,0x0,0x0,0x0,0x0,0x0,0x0
.long 0xbc000000,0x3c000000,0x0,0x0,0x3c00,0xbc00,0x0,0x0
.long 0x3c003c00,0x3c003c00,0x0,0x0,0x0,0x0,0x0,0x0
.long 0x0,0x0,0xbc000000,0x3c000000,0x0,0x0,0x3c00,0xbc00
.long 0x0,0x0,0x3c003c00,0x3c003c00,0x0,0x0,0x0,0x0
.long 0xbc003c00,0xbc003c00,0x0,0x0,0x0,0x0,0x0,0x0
.long 0x0,0x0,0xbc003c00,0xbc003c00,0x0,0x0,0x0,0x0
.long 0x0,0x0,0x0,0x0,0x0,0x0,0x0,0x0
.long 0x0,0x0,0x0,0x0,0x0,0x0,0x0,0x0
.long 0x0,0x0,0x0,0x0,0x0,0x0,0x0,0x0
.long 0x0,0x0,0x0,0x0,0x0,0x0,0x0,0x0
.long 0x0,0x0,0x0,0x0,0x0,0x0,0x0,0x0
.long 0x0,0x0,0x0,0x0,0x0,0x0,0x0,0x0
.long 0x3c00bc00,0x3c00bc00,0x0,0x0,0x0,0x0,0x0,0x0
.long 0x0,0x0,0x3c00bc00,0x3c00bc00,0x0,0x0,0x0,0x0
.long 0x0,0x0,0x0,0x0,0x0,0x0,0x0,0x0
.long 0x0,0x0,0x0,0x0,0x0,0x0,0x0,0x0
.long 0x0,0x0,0x0,0x0,0x0,0x0,0x0,0x0
.long 0x0,0x0,0x0,0x0,0x0,0x0,0x0,0x0
.long 0x0,0x0,0x0,0x0,0x0,0x0,0x0,0x0
.long 0x0,0x0,0x0,0x0,0x0,0x0,0x0,0x0
.long 0x0,0x0,0x0,0x0,0x0,0x0,0x0,0x0
.long 0x0,0x0,0x0,0x0,0x0,0x0,0x0,0x0
.long 0xbc003c00,0xbc003c00,0x0,0x0,0x0,0x0,0x0,0x0
.long 0x0,0x0,0xbc003c00,0xbc003c00,0x0,0x0,0x0,0x0
.long 0x0,0x0,0x0,0x0,0x0,0x0,0x0,0x0
.long 0x0,0x0,0x0,0x0,0x0,0x0,0x0,0x0
.long 0x0,0x0,0x0,0x0,0x0,0x0,0x0,0x0
.long 0x0,0x0,0x0,0x0,0x0,0x0,0x0,0x0
.long 0x0,0x0,0x0,0x0,0x0,0x0,0x0,0x0
.long 0x0,0x0,0x0,0x0,0x0,0x0,0x0,0x0
.long 0x3c00bc00,0x3c00bc00,0x0,0x0,0x0,0x0,0x0,0x0
.long 0x0,0x0,0x3c00bc00,0x3c00bc00,0x0,0x0,0x0,0x0
.long 0x0,0x0,0x0,0x0,0x0,0x0,0x0,0x0
.long 0x0,0x0,0x0,0x0,0x0,0x0,0x0,0x0
.long 0x0,0x0,0x0,0x0,0x0,0x0,0x0,0x0
.long 0x0,0x0,0x0,0x0,0x0,0x0,0x0,0x0
.long 0x0,0x0,0x0,0x0,0x0,0x0,0x0,0x0
.long 0x0,0x0,0x0,0x0,0x0,0x0,0x0,0x0
.long 0x0,0x0,0x0,0x0,0x0,0x0,0x0,0x0
.long 0x0,0x0,0x0,0x0,0x0,0x0,0x0,0x0
.long 0xbc003c00,0xbc003c00,0x0,0x0,0x0,0x0,0x0,0x0
.long 0x0,0x0,0xbc003c00,0xbc003c00,0x0,0x0,0x0,0x0
.long 0x0,0x0,0x0,0x0,0x0,0x0,0x0,0x0
.long 0x0,0x0,0x0,0x0,0x0,0x0,0x0,0x0
.long 0x0,0x0,0x0,0x0,0x0,0x0,0x0,0x0
.long 0x0,0x0,0x0,0x0,0x0,0x0,0x0,0x0
.long 0x0,0x0,0x0,0x0,0x0,0x0,0x0,0x0
.long 0x0,0x0,0x0,0x0,0x0,0x0,0x0,0x0
.long 0x3c00bc00,0x3c00bc00,0x0,0x0,0x0,0x0,0x0,0x0
.long 0x0,0x0,0x3c00bc00,0x3c00bc00,0x0,0x0,0x0,0x0
.long 0x0,0x0,0x0,0x0,0x0,0x0,0x0,0x0
.long 0x0,0x0,0x0,0x0,0x0,0x0,0x0,0x0
.long 0x0,0x0,0x0,0x0,0x0,0x0,0x0,0x0
.long 0x0,0x0,0x0,0x0,0x0,0x0,0x0,0x0
.long 0x0,0x0,0x0,0x0,0x0,0x0,0x0,0x0
.long 0x0,0x0,0x0,0x0,0x0,0x0,0x0,0x0
.long 0x0,0x0,0x0,0x0,0x0,0x0,0x0,0x0
.long 0x0,0x0,0x0,0x0,0x0,0x0,0x0,0x0
.long 0xbc003c00,0xbc003c00,0x0,0x0,0x0,0x0,0x0,0x0
.long 0x0,0x0,0xbc003c00,0xbc003c00,0x0,0x0,0x0,0x0
.long 0x0,0x0,0x0,0x0,0x0,0x0,0x0,0x0
.long 0x0,0x0,0x0,0x0,0x0,0x0,0x0,0x0
.long 0x0,0x0,0x0,0x0,0x0,0x0,0x0,0x0
.long 0x0,0x0,0x0,0x0,0x0,0x0,0x0,0x0
.long 0x0,0x0,0x0,0x0,0x0,0x0,0x0,0x0
.long 0x0,0x0,0x0,0x0,0x0,0x0,0x0,0x0
.long 0x3c00bc00,0x3c00bc00,0x0,0x0,0x0,0x0,0x0,0x0
.long 0x0,0x0,0x3c00bc00,0x3c00bc00,0x0,0x0,0x0,0x0
.long 0x3c00,0xbc00,0x0,0x0,0xbc000000,0x3c000000,0x0,0x0
.long 0x3c003c00,0x3c003c00,0x0,0x0,0x0,0x0,0x0,0x0
.long 0x0,0x0,0x0,0x0,0x0,0x0,0x0,0x0
.long 0x0,0x0,0x0,0x0,0x0,0x0,0x0,0x0
.long 0xbc003c00,0xbc003c00,0x0,0x0,0x0,0x0,0x0,0x0
.long 0x0,0x0,0x0,0x0,0x0,0x0,0x0,0x0
.long 0x0,0x0,0x0,0x0,0x0,0x0,0x0,0x0
.long 0x0,0x0,0x0,0x0,0x0,0x0,0x0,0x0
.long 0xbc000000,0x3c000000,0x0,0x0,0x3c00,0xbc00,0x0,0x0
.long 0x3c003c00,0x3c003c00,0x0,0x0,0x0,0x0,0x0,0x0
.long 0x0,0x0,0x0,0x0,0x0,0x0,0x0,0x0
.long 0x0,0x0,0x0,0x0,0x0,0x0,0x0,0x0
.long 0x3c00bc00,0x3c00bc00,0x0,0x0,0x0,0x0,0x0,0x0
.long 0x0,0x0,0x0,0x0,0x0,0x0,0x0,0x0
.long 0x0,0x0,0x0,0x0,0x0,0x0,0x0,0x0
.long 0x0,0x0,0x0,0x0,0x0,0x0,0x0,0x0
.long 0x0,0x0,0x0,0x0,0x0,0x0,0x0,0x0
.long 0x0,0x0,0x0,0x0,0x0,0x0,0x0,0x0
.long 0x3c00,0xbc00,0x0,0x0,0xbc000000,0x3c000000,0x0,0x0
.long 0x3c003c00,0x3c003c00,0x0,0x0,0x0,0x0,0x0,0x0
.long 0x0,0x0,0x0,0x0,0x0,0x0,0x0,0x0
.long 0xbc003c00,0xbc003c00,0x0,0x0,0x0,0x0,0x0,0x0
.long 0x0,0x0,0x0,0x0,0x0,0x0,0x0,0x0
.long 0x0,0x0,0x0,0x0,0x0,0x0,0x0,0x0
.long 0x0,0x0,0x0,0x0,0x0,0x0,0x0,0x0
.long 0x0,0x0,0x0,0x0,0x0,0x0,0x0,0x0
.long 0xbc000000,0x3c000000,0x0,0x0,0x3c00,0xbc00,0x0,0x0
.long 0x3c003c00,0x3c003c00,0x0,0x0,0x0,0x0,0x0,0x0
.long 0x0,0x0,0x0,0x0,0x0,0x0,0x0,0x0
.long 0x3c00bc00,0x3c00bc00,0x0,0x0,0x0,0x0,0x0,0x0
.long 0x0,0x0,0x0,0x0,0x0,0x0,0x0,0x0
.long 0x0,0x0,0x0,0x0,0x0,0x0,0x0,0x0
.long 0x48004800,0x4800,0x4800,0x4800,0x48004800,0x48000000,0xc800,0x48000000
.long 0x48004800,0xc800,0x4800,0xc800,0x48004800,0xc8008000,0xc800,0xc8008000
.long 0x48004800,0xc8008000,0xc800,0xc8008000,0x48004800,0xc800,0x4800,0xc800
.long 0x48004800,0x48000000,0xc800,0x48000000,0x48004800,0x4800,0x4800,0x4800
.long 0x0,0x0,0x0,0x0,0x0,0x0,0x0,0x0
.long 0x0,0x0,0x0,0x0,0x0,0x0,0x0,0x0
.long 0x0,0x0,0x0,0x0,0x0,0x0,0x0,0x0
.long 0x0,0x0,0x0,0x0,0x0,0x0,0x0,0x0
.long 0x4800,0x4800,0x4800,0x4800,0x4800,0x48000000,0xc800,0x48000000
.long 0x4800,0xc800,0x4800,0xc800,0x4800,0xc8008000,0xc800,0xc8008000
.long 0x4800,0xc8008000,0xc800,0xc8008000,0x4800,0xc800,0x4800,0xc800
.long 0x4800,0x48000000,0xc800,0x48000000,0x4800,0x4800,0x4800,0x4800
.long 0x0,0x0,0x0,0x0,0x0,0x0,0x0,0x0
.long 0x0,0x0,0x0,0x0,0x0,0x0,0x0,0x0
.long 0x0,0x0,0x0,0x0,0x0,0x0,0x0,0x0
.long 0x0,0x0,0x0,0x0,0x0,0x0,0x0,0x0
.long 0x0,0x0,0x0,0x0,0x0,0x0,0x0,0x0
.long 0x0,0x0,0x0,0x0,0x0,0x0,0x0,0x0
.long 0x0,0x0,0x0,0x0,0x0,0x0,0x0,0x0
.long 0x0,0x0,0x0,0x0,0x0,0x0,0x0,0x0
.long 0x48004800,0x4800,0x4800,0x4800,0x48004800,0x48000000,0xc800,0x48000000
.long 0x48004800,0xc800,0x4800,0xc800,0x48004800,0xc8008000,0xc800,0xc8008000
.long 0x48004800,0xc8008000,0xc800,0xc8008000,0x48004800,0xc800,0x4800,0xc800
.long 0x48004800,0x48000000,0xc800,0x48000000,0x48004800,0x4800,0x4800,0x4800
.long 0x0,0x0,0x0,0x0,0x0,0x0,0x0,0x0
.long 0x0,0x0,0x0,0x0,0x0,0x0,0x0,0x0
.long 0x0,0x0,0x0,0x0,0x0,0x0,0x0,0x0
.long 0x0,0x0,0x0,0x0,0x0,0x0,0x0,0x0
.long 0x4800,0x4800,0x4800,0x4800,0x4800,0x48000000,0xc800,0x48000000
.long 0x4800,0xc800,0x4800,0xc800,0x4800,0xc8008000,0xc800,0xc8008000
.long 0x4800,0xc8008000,0xc800,0xc8008000,0x4800,0xc800,0x4800,0xc800
.long 0x4800,0x48000000,0xc800,0x48000000,0x4800,0x4800,0x4800,0x4800
.long 0x3c00,0x3c00,0x3c00,0x3c00,0x3c00,0x361f3b64,0x39a839a8,0x3b64361f
.long 0x3c00,0x39a839a8,0x3c000000,0x39a8b9a8,0x3c00,0x3b64361f,0x39a8b9a8,0xb61fbb64
.long 0x3c00,0x3c000000,0xbc00,0xbc008000,0x3c00,0x3b64b61f,0xb9a8b9a8,0xb61f3b64
.long 0x3c00,0x39a8b9a8,0xbc008000,0x39a839a8,0x3c00,0x361fbb64,0xb9a839a8,0x3b64b61f
.long 0x3c00,0xbc00,0x3c00,0xbc00,0x3c00,0xb61fbb64,0x39a839a8,0xbb64b61f
.long 0x3c00,0xb9a8b9a8,0x3c000000,0xb9a839a8,0x3c00,0xbb64b61f,0x39a8b9a8,0x361f3b64
.long 0x3c00,0xbc008000,0xbc00,0x3c000000,0x3c00,0xbb64361f,0xb9a8b9a8,0x361fbb64
.long 0x3c00,0xb9a839a8,0xbc008000,0xb9a8b9a8,0x3c00,0xb61f3b64,0xb9a839a8,0xbb64361f
.long 0x3c00,0x3c00,0x3c00,0x3c00,0x3c000000,0x3b64b61f,0x39a8b9a8,0x361fbb64
.long 0xbc00,0xb9a8b9a8,0xbc008000,0xb9a839a8,0xbc008000,0xb61f3b64,0x39a839a8,0x3b64b61f
.long 0x3c00,0x3c000000,0xbc00,0xbc008000,0x3c000000,0xb61fbb64,0xb9a839a8,0x3b64361f
.long 0xbc00,0xb9a839a8,0x3c000000,0xb9a8b9a8,0xbc008000,0x3b64361f,0xb9a8b9a8,0x361f3b64
.long 0x3c00,0xbc00,0x3c00,0xbc00,0x3c000000,0xbb64361f,0x39a8b9a8,0xb61f3b64
.long 0xbc00,0x39a839a8,0xbc008000,0x39a8b9a8,0xbc008000,0x361fbb64,0x39a839a8,0xbb64361f
.long 0x3c00,0xbc008000,0xbc00,0x3c000000,0x3c000000,0x361f3b64,0xb9a839a8,0xbb64b61f
.long 0xbc00,0x39a8b9a8,0x3c000000,0x39a839a8,0xbc008000,0xbb64b61f,0xb9a8b9a8,0xb61fbb64
.long 0x3c00,0x3c00,0x3c00,0x3c00,0xbc00,0xb61fbb64,0xb9a8b9a8,0xbb64b61f
.long 0x3c00,0x39a839a8,0x3c000000,0x39a8b9a8,0xbc00,0xbb64b61f,0xb9a839a8,0x361f3b64
.long 0x3c00,0x3c000000,0xbc00,0xbc008000,0xbc00,0xbb64361f,0x39a839a8,0x361fbb64
.long 0x3c00,0x39a8b9a8,0xbc008000,0x39a839a8,0xbc00,0xb61f3b64,0x39a8b9a8,0xbb64361f
.long 0x3c00,0xbc00,0x3c00,0xbc00,0xbc00,0x361f3b64,0xb9a8b9a8,0x3b64361f
.long 0x3c00,0xb9a8b9a8,0x3c000000,0xb9a839a8,0xbc00,0x3b64361f,0xb9a839a8,0xb61fbb64
.long 0x3c00,0xbc008000,0xbc00,0x3c000000,0xbc00,0x3b64b61f,0x39a839a8,0xb61f3b64
.long 0x3c00,0xb9a839a8,0xbc008000,0xb9a8b9a8,0xbc00,0x361fbb64,0x39a8b9a8,0x3b64b61f
.long 0x3c00,0x3c00,0x3c00,0x3c00,0xbc008000,0xbb64361f,0xb9a839a8,0xb61f3b64
.long 0xbc00,0xb9a8b9a8,0xbc008000,0xb9a839a8,0x3c000000,0x361fbb64,0xb9a8b9a8,0xbb64361f
.long 0x3c00,0x3c000000,0xbc00,0xbc008000,0xbc008000,0x361f3b64,0x39a8b9a8,0xbb64b61f
.long 0xbc00,0xb9a839a8,0x3c000000,0xb9a8b9a8,0x3c000000,0xbb64b61f,0x39a839a8,0xb61fbb64
.long 0x3c00,0xbc00,0x3c00,0xbc00,0xbc008000,0x3b64b61f,0xb9a839a8,0x361fbb64
.long 0xbc00,0x39a839a8,0xbc008000,0x39a8b9a8,0x3c000000,0xb61f3b64,0xb9a8b9a8,0x3b64b61f
.long 0x3c00,0xbc008000,0xbc00,0x3c000000,0xbc008000,0xb61fbb64,0x39a8b9a8,0x3b64361f
.long 0xbc00,0x39a8b9a8,0x3c000000,0x39a839a8,0x3c000000,0x3b64361f,0x39a839a8,0x361f3b64
.long 0x3c008000,0x3c008000,0x3c008000,0x3c008000,0x3c008000,0x3b64b61f,0x39a8b9a8,0x361fbb64
.long 0x3c008000,0x39a8b9a8,0xbc00,0xb9a8b9a8,0x3c008000,0x361fbb64,0xb9a8b9a8,0xbb64361f
.long 0x3c008000,0xbc00,0xbc008000,0x80003c00,0x3c008000,0xb61fbb64,0xb9a839a8,0x3b64361f
.long 0x3c008000,0xb9a8b9a8,0x80003c00,0x39a8b9a8,0x3c008000,0xbb64b61f,0x39a839a8,0xb61fbb64
.long 0x3c008000,0xbc008000,0x3c008000,0xbc008000,0x3c008000,0xbb64361f,0x39a8b9a8,0xb61f3b64
.long 0x3c008000,0xb9a839a8,0xbc00,0x39a839a8,0x3c008000,0xb61f3b64,0xb9a8b9a8,0x3b64b61f
.long 0x3c008000,0x80003c00,0xbc008000,0xbc00,0x3c008000,0x361f3b64,0xb9a839a8,0xbb64b61f
.long 0x3c008000,0x39a839a8,0x80003c00,0xb9a839a8,0x3c008000,0x3b64361f,0x39a839a8,0x361f3b64
.long 0x3c008000,0x3c008000,0x3c008000,0x3c008000,0xbc00,0xb61fbb64,0xb9a8b9a8,0xbb64b61f
.long 0xbc008000,0xb9a839a8,0x80003c00,0x39a839a8,0x80003c00,0x3b64361f,0x39a8b9a8,0xb61fbb64
.long 0x3c008000,0xbc00,0xbc008000,0x80003c00,0xbc00,0xbb64361f,0x39a839a8,0x361fbb64
.long 0xbc008000,0x39a839a8,0xbc00,0xb9a839a8,0x80003c00,0x361fbb64,0xb9a839a8,0x3b64b61f
.long 0x3c008000,0xbc008000,0x3c008000,0xbc008000,0xbc00,0x361f3b64,0xb9a8b9a8,0x3b64361f
.long 0xbc008000,0x39a8b9a8,0x80003c00,0xb9a8b9a8,0x80003c00,0xbb64b61f,0x39a8b9a8,0x361f3b64
.long 0x3c008000,0x80003c00,0xbc008000,0xbc00,0xbc00,0x3b64b61f,0x39a839a8,0xb61f3b64
.long 0xbc008000,0xb9a8b9a8,0xbc00,0x39a8b9a8,0x80003c00,0xb61f3b64,0xb9a839a8,0xbb64361f
.long 0x3c008000,0x3c008000,0x3c008000,0x3c008000,0xbc008000,0xbb64361f,0xb9a839a8,0xb61f3b64
.long 0x3c008000,0x39a8b9a8,0xbc00,0xb9a8b9a8,0xbc008000,0xb61f3b64,0x39a839a8,0x3b64b61f
.long 0x3c008000,0xbc00,0xbc008000,0x80003c00,0xbc008000,0x361f3b64,0x39a8b9a8,0xbb64b61f
.long 0x3c008000,0xb9a8b9a8,0x80003c00,0x39a8b9a8,0xbc008000,0x3b64361f,0xb9a8b9a8,0x361f3b64
.long 0x3c008000,0xbc008000,0x3c008000,0xbc008000,0xbc008000,0x3b64b61f,0xb9a839a8,0x361fbb64
.long 0x3c008000,0xb9a839a8,0xbc00,0x39a839a8,0xbc008000,0x361fbb64,0x39a839a8,0xbb64361f
.long 0x3c008000,0x80003c00,0xbc008000,0xbc00,0xbc008000,0xb61fbb64,0x39a8b9a8,0x3b64361f
.long 0x3c008000,0x39a839a8,0x80003c00,0xb9a839a8,0xbc008000,0xbb64b61f,0xb9a8b9a8,0xb61fbb64
.long 0x3c008000,0x3c008000,0x3c008000,0x3c008000,0x80003c00,0x361f3b64,0x39a839a8,0x3b64361f
.long 0xbc008000,0xb9a839a8,0x80003c00,0x39a839a8,0xbc00,0xbb64b61f,0xb9a839a8,0x361f3b64
.long 0x3c008000,0xbc00,0xbc008000,0x80003c00,0x80003c00,0x3b64b61f,0xb9a8b9a8,0xb61f3b64
.long 0xbc008000,0x39a839a8,0xbc00,0xb9a839a8,0xbc00,0xb61f3b64,0x39a8b9a8,0xbb64361f
.long 0x3c008000,0xbc008000,0x3c008000,0xbc008000,0x80003c00,0xb61fbb64,0x39a839a8,0xbb64b61f
.long 0xbc008000,0x39a8b9a8,0x80003c00,0xb9a8b9a8,0xbc00,0x3b64361f,0xb9a839a8,0xb61fbb64
.long 0x3c008000,0x80003c00,0xbc008000,0xbc00,0x80003c00,0xbb64361f,0xb9a8b9a8,0x361fbb64
.long 0xbc008000,0xb9a8b9a8,0xbc00,0x39a8b9a8,0xbc00,0x361fbb64,0x39a8b9a8,0x3b64b61f
.long 0x3000,0x3000,0x3000,0x3000,0x30008000,0x30008000,0x30008000,0x30008000
.long 0x3000,0x25022fe7,0x28f22f9c,0x2b442f21,0x30008000,0x2fe7a502,0x2f9ca8f2,0x2f21ab44
.long 0x3000,0x28f22f9c,0x2cb42e79,0x2e792cb4,0x30008000,0x2f9ca8f2,0x2e79acb4,0x2cb4ae79
.long 0x3000,0x2b442f21,0x2e792cb4,0x2fe72502,0x30008000,0x2f21ab44,0x2cb4ae79,0x2502afe7
.long 0x3000,0x2cb42e79,0x2f9c28f2,0x2f9ca8f2,0x30008000,0x2e79acb4,0x28f2af9c,0xa8f2af9c
.long 0x3000,0x2da82da8,0x30000000,0x2da8ada8,0x30008000,0x2da8ada8,0xb000,0xada8ada8
.long 0x3000,0x2e792cb4,0x2f9ca8f2,0x28f2af9c,0x30008000,0x2cb4ae79,0xa8f2af9c,0xaf9ca8f2
.long 0x3000,0x2f212b44,0x2e79acb4,0xa502afe7,0x30008000,0x2b44af21,0xacb4ae79,0xafe72502
.long 0x3000,0x3000,0x3000,0x3000,0x30008000,0x30008000,0x30008000,0x30008000
.long 0x2cb42e79,0x2da82da8,0x2e792cb4,0x2f212b44,0x2e79acb4,0x2da8ada8,0x2cb4ae79,0x2b44af21
.long 0x2f9c28f2,0x30000000,0x2f9ca8f2,0x2e79acb4,0x28f2af9c,0xb000,0xa8f2af9c,0xacb4ae79
.long 0x2f9ca8f2,0x2da8ada8,0x28f2af9c,0xa502afe7,0xa8f2af9c,0xada8ada8,0xaf9ca8f2,0xafe72502
.long 0x2cb4ae79,0xb000,0xacb4ae79,0xaf9ca8f2,0xae79acb4,0xb0008000,0xae792cb4,0xa8f22f9c
.long 0xb000,0xada8ada8,0xb0008000,0xada82da8,0xb0008000,0xada82da8,0x80003000,0x2da82da8
.long 0xacb4ae79,0xb0008000,0xacb42e79,0x28f22f9c,0xae792cb4,0x80003000,0x2e792cb4,0x2f9ca8f2
.long 0xaf9ca8f2,0xada82da8,0x28f22f9c,0x2fe72502,0xa8f22f9c,0x2da82da8,0x2f9ca8f2,0x2502afe7
.long 0x3000,0x3000,0x3000,0x3000,0x30008000,0x30008000,0x30008000,0x30008000
.long 0x2f9c28f2,0x2fe72502,0x30000000,0x2fe7a502,0x28f2af9c,0x2502afe7,0xb000,0xa502afe7
.long 0x2cb4ae79,0x28f2af9c,0xb000,0xa8f2af9c,0xae79acb4,0xaf9ca8f2,0xb0008000,0xaf9c28f2
.long 0xacb4ae79,0xaf21ab44,0xb0008000,0xaf212b44,0xae792cb4,0xab442f21,0x80003000,0x2b442f21
.long 0xaf9c28f2,0xacb42e79,0x3000,0x2cb42e79,0x28f22f9c,0x2e792cb4,0x30008000,0x2e79acb4
.long 0x3000,0x2da82da8,0x30000000,0x2da8ada8,0x30008000,0x2da8ada8,0xb000,0xada8ada8
.long 0x2f9c28f2,0x2e79acb4,0xb000,0xae79acb4,0x28f2af9c,0xacb4ae79,0xb0008000,0xacb42e79
.long 0x2cb4ae79,0xab44af21,0xb0008000,0xab442f21,0xae79acb4,0xaf212b44,0x80003000,0x2f212b44
.long 0x3000,0x3000,0x3000,0x3000,0x30008000,0x30008000,0x30008000,0x30008000
.long 0x2f9ca8f2,0x2f21ab44,0x2e79acb4,0x2da8ada8,0xa8f2af9c,0xab44af21,0xacb4ae79,0xada8ada8
.long 0xacb4ae79,0xae79acb4,0xaf9ca8f2,0xb0008000,0xae792cb4,0xacb42e79,0xa8f22f9c,0x80003000
.long 0xacb42e79,0xa5022fe7,0x28f22f9c,0x2da82da8,0x2e792cb4,0x2fe72502,0x2f9ca8f2,0x2da8ada8
.long 0x2f9c28f2,0x2f9ca8f2,0x2cb4ae79,0xb000,0x28f2af9c,0xa8f2af9c,0xae79acb4,0xb0008000
.long 0xb000,0xada8ada8,0xb0008000,0xada82da8,0xb0008000,0xada82da8,0x80003000,0x2da82da8
.long 0xaf9c28f2,0xa8f22f9c,0x2cb42e79,0x30000000,0x28f22f9c,0x2f9c28f2,0x2e79acb4,0xb000
.long 0x2cb42e79,0x2fe7a502,0x28f2af9c,0xada8ada8,0x2e79acb4,0xa502afe7,0xaf9ca8f2,0xada82da8
.long 0x3000,0x3000,0x3000,0x3000,0x30008000,0x30008000,0x30008000,0x30008000
.long 0x2cb4ae79,0x2b44af21,0x28f2af9c,0x2502afe7,0xae79acb4,0xaf21ab44,0xaf9ca8f2,0xafe7a502
.long 0xaf9c28f2,0xae792cb4,0xacb42e79,0xa8f22f9c,0x28f22f9c,0x2cb42e79,0x2e792cb4,0x2f9c28f2
.long 0x2f9c28f2,0x2fe7a502,0x2e79acb4,0x2b44af21,0x28f2af9c,0xa502afe7,0xacb4ae79,0xaf21ab44
.long 0xacb4ae79,0xaf9ca8f2,0xaf9c28f2,0xacb42e79,0xae792cb4,0xa8f22f9c,0x28f22f9c,0x2e792cb4
.long 0x3000,0x2da82da8,0x30000000,0x2da8ada8,0x30008000,0x2da8ada8,0xb000,0xada8ada8
.long 0x2cb4ae79,0xa8f2af9c,0xaf9ca8f2,0xae792cb4,0xae79acb4,0xaf9c28f2,0xa8f22f9c,0x2cb42e79
.long 0xaf9c28f2,0xa5022fe7,0x2e792cb4,0x2f21ab44,0x28f22f9c,0x2fe72502,0x2cb4ae79,0xab44af21
.long 0x3000,0x3000,0x3000,0x3000,0x30008000,0x30008000,0x30008000,0x30008000
.long 0xb000,0xa502afe7,0xa8f2af9c,0xab44af21,0xb0008000,0xafe72502,0xaf9c28f2,0xaf212b44
.long 0x3000,0x28f22f9c,0x2cb42e79,0x2e792cb4,0x30008000,0x2f9ca8f2,0x2e79acb4,0x2cb4ae79
.long 0xb000,0xab44af21,0xae79acb4,0xafe7a502,0xb0008000,0xaf212b44,0xacb42e79,0xa5022fe7
.long 0x3000,0x2cb42e79,0x2f9c28f2,0x2f9ca8f2,0x30008000,0x2e79acb4,0x28f2af9c,0xa8f2af9c
.long 0xb000,0xada8ada8,0xb0008000,0xada82da8,0xb0008000,0xada82da8,0x80003000,0x2da82da8
.long 0x3000,0x2e792cb4,0x2f9ca8f2,0x28f2af9c,0x30008000,0x2cb4ae79,0xa8f2af9c,0xaf9ca8f2
.long 0xb000,0xaf21ab44,0xae792cb4,0x25022fe7,0xb0008000,0xab442f21,0x2cb42e79,0x2fe7a502
.long 0x3000,0x3000,0x3000,0x3000,0x30008000,0x30008000,0x30008000,0x30008000
.long 0xacb4ae79,0xada8ada8,0xae79acb4,0xaf21ab44,0xae792cb4,0xada82da8,0xacb42e79,0xab442f21
.long 0x2f9c28f2,0x30000000,0x2f9ca8f2,0x2e79acb4,0x28f2af9c,0xb000,0xa8f2af9c,0xacb4ae79
.long 0xaf9c28f2,0xada82da8,0xa8f22f9c,0x25022fe7,0x28f22f9c,0x2da82da8,0x2f9c28f2,0x2fe7a502
.long 0x2cb4ae79,0xb000,0xacb4ae79,0xaf9ca8f2,0xae79acb4,0xb0008000,0xae792cb4,0xa8f22f9c
.long 0x3000,0x2da82da8,0x30000000,0x2da8ada8,0x30008000,0x2da8ada8,0xb000,0xada8ada8
.long 0xacb4ae79,0xb0008000,0xacb42e79,0x28f22f9c,0xae792cb4,0x80003000,0x2e792cb4,0x2f9ca8f2
.long 0x2f9c28f2,0x2da8ada8,0xa8f2af9c,0xafe7a502,0x28f2af9c,0xada8ada8,0xaf9c28f2,0xa5022fe7
.long 0x3000,0x3000,0x3000,0x3000,0x30008000,0x30008000,0x30008000,0x30008000
.long 0xaf9ca8f2,0xafe7a502,0xb0008000,0xafe72502,0xa8f22f9c,0xa5022fe7,0x80003000,0x25022fe7
.long 0x2cb4ae79,0x28f2af9c,0xb000,0xa8f2af9c,0xae79acb4,0xaf9ca8f2,0xb0008000,0xaf9c28f2
.long 0x2cb42e79,0x2f212b44,0x30000000,0x2f21ab44,0x2e79acb4,0x2b44af21,0xb000,0xab44af21
.long 0xaf9c28f2,0xacb42e79,0x3000,0x2cb42e79,0x28f22f9c,0x2e792cb4,0x30008000,0x2e79acb4
.long 0xb000,0xada8ada8,0xb0008000,0xada82da8,0xb0008000,0xada82da8,0x80003000,0x2da82da8
.long 0x2f9c28f2,0x2e79acb4,0xb000,0xae79acb4,0x28f2af9c,0xacb4ae79,0xb0008000,0xacb42e79
.long 0xacb42e79,0x2b442f21,0x30000000,0x2b44af21,0x2e792cb4,0x2f21ab44,0xb000,0xaf21ab44
.long 0x3000,0x3000,0x3000,0x3000,0x30008000,0x30008000,0x30008000,0x30008000
.long 0xaf9c28f2,0xaf212b44,0xae792cb4,0xada82da8,0x28f22f9c,0x2b442f21,0x2cb42e79,0x2da82da8
.long 0xacb4ae79,0xae79acb4,0xaf9ca8f2,0xb0008000,0xae792cb4,0xacb42e79,0xa8f22f9c,0x80003000
.long 0x2cb4ae79,0x2502afe7,0xa8f2af9c,0xada8ada8,0xae79acb4,0xafe7a502,0xaf9c28f2,0xada82da8
.long 0x2f9c28f2,0x2f9ca8f2,0x2cb4ae79,0xb000,0x28f2af9c,0xa8f2af9c,0xae79acb4,0xb0008000
.long 0x3000,0x2da82da8,0x30000000,0x2da8ada8,0x30008000,0x2da8ada8,0xb000,0xada8ada8
.long 0xaf9c28f2,0xa8f22f9c,0x2cb42e79,0x30000000,0x28f22f9c,0x2f9c28f2,0x2e79acb4,0xb000
.long 0xacb4ae79,0xafe72502,0xa8f22f9c,0x2da82da8,0xae792cb4,0x25022fe7,0x2f9c28f2,0x2da8ada8
.long 0x3000,0x3000,0x3000,0x3000,0x30008000,0x30008000,0x30008000,0x30008000
.long 0xacb42e79,0xab442f21,0xa8f22f9c,0xa5022fe7,0x2e792cb4,0x2f212b44,0x2f9c28f2,0x2fe72502
.long 0xaf9c28f2,0xae792cb4,0xacb42e79,0xa8f22f9c,0x28f22f9c,0x2cb42e79,0x2e792cb4,0x2f9c28f2
.long 0xaf9ca8f2,0xafe72502,0xae792cb4,0xab442f21,0xa8f22f9c,0x25022fe7,0x2cb42e79,0x2f212b44
.long 0xacb4ae79,0xaf9ca8f2,0xaf9c28f2,0xacb42e79,0xae792cb4,0xa8f22f9c,0x28f22f9c,0x2e792cb4
.long 0xb000,0xada8ada8,0xb0008000,0xada82da8,0xb0008000,0xada82da8,0x80003000,0x2da82da8
.long 0x2cb4ae79,0xa8f2af9c,0xaf9ca8f2,0xae792cb4,0xae79acb4,0xaf9c28f2,0xa8f22f9c,0x2cb42e79
.long 0x2f9ca8f2,0x2502afe7,0xae79acb4,0xaf212b44,0xa8f2af9c,0xafe7a502,0xacb42e79,0x2b442f21
.long 0x0,0x0,0x0,0x0,0x0,0x0,0x0,0x0
.long 0x0,0x0,0x0,0x0,0x0,0x0,0x0,0x0
.long 0x0,0x0,0x0,0x0,0x0,0x0,0x0,0x0
.long 0x0,0x0,0x0,0x0,0x0,0x0,0x0,0x0
.long 0x0,0x0,0x0,0x0,0x0,0x0,0x0,0x0
.long 0x0,0x0,0x0,0x0,0x0,0x0,0x0,0x0
.long 0x0,0x0,0x0,0x0,0x0,0x0,0x0,0x0
.long 0x0,0x0,0x0,0x0,0x0,0x0,0x0,0x0
.long 0x0,0x0,0x0,0x0,0x0,0x0,0x0,0x0
.long 0x0,0x0,0x0,0x0,0x0,0x0,0x0,0x0
.long 0x0,0x0,0x0,0x0,0x0,0x0,0x0,0x0
.long 0x0,0x0,0x0,0x0,0x0,0x0,0x0,0x0
.long 0x0,0x0,0x0,0x0,0x0,0x0,0x0,0x0
.long 0x0,0x0,0x0,0x0,0x0,0x0,0x0,0x0
.long 0x0,0x0,0x0,0x0,0x0,0x0,0x0,0x0
.long 0x0,0x0,0x0,0x0,0x0,0x0,0x0,0x0
.long 0x3000,0x2f9c28f2,0x2cb4ae79,0xacb4ae79,0x30008000,0x28f2af9c,0xae79acb4,0xae792cb4
.long 0x3000,0x2fe72502,0x28f2af9c,0xaf21ab44,0x30008000,0x2502afe7,0xaf9ca8f2,0xab442f21
.long 0x3000,0x30000000,0xb000,0xb0008000,0x30008000,0xb000,0xb0008000,0x80003000
.long 0x3000,0x2fe7a502,0xa8f2af9c,0xaf212b44,0x30008000,0xa502afe7,0xaf9c28f2,0x2b442f21
.long 0x3000,0x2f9ca8f2,0xacb4ae79,0xacb42e79,0x30008000,0xa8f2af9c,0xae792cb4,0x2e792cb4
.long 0x3000,0x2f21ab44,0xae79acb4,0xa5022fe7,0x30008000,0xab44af21,0xacb42e79,0x2fe72502
.long 0x3000,0x2e79acb4,0xaf9ca8f2,0x28f22f9c,0x30008000,0xacb4ae79,0xa8f22f9c,0x2f9ca8f2
.long 0x3000,0x2da8ada8,0xb0008000,0x2da82da8,0x30008000,0xada8ada8,0x80003000,0x2da8ada8
.long 0xaf9c28f2,0x3000,0x2f9c28f2,0x2cb4ae79,0x28f22f9c,0x30008000,0x28f2af9c,0xae79acb4
.long 0xacb42e79,0x2da82da8,0x2e79acb4,0xab44af21,0x2e792cb4,0x2da8ada8,0xacb4ae79,0xaf212b44
.long 0x3000,0x30000000,0xb000,0xb0008000,0x30008000,0xb000,0xb0008000,0x80003000
.long 0x2cb42e79,0x2da8ada8,0xae79acb4,0xab442f21,0x2e79acb4,0xada8ada8,0xacb42e79,0x2f212b44
.long 0x2f9c28f2,0xb000,0xaf9c28f2,0x2cb42e79,0x28f2af9c,0xb0008000,0x28f22f9c,0x2e79acb4
.long 0x2f9ca8f2,0xada8ada8,0xa8f22f9c,0x2fe7a502,0xa8f2af9c,0xada82da8,0x2f9c28f2,0xa502afe7
.long 0x2cb4ae79,0xb0008000,0x2cb42e79,0x28f2af9c,0xae79acb4,0x80003000,0x2e79acb4,0xaf9ca8f2
.long 0xb000,0xada82da8,0x30000000,0xada8ada8,0xb0008000,0x2da82da8,0xb000,0xada82da8
.long 0xacb4ae79,0xaf9c28f2,0x3000,0x2f9c28f2,0xae792cb4,0x28f22f9c,0x30008000,0x28f2af9c
.long 0xaf9c28f2,0x25022fe7,0x30000000,0x2502afe7,0x28f22f9c,0x2fe7a502,0xb000,0xafe7a502
.long 0x3000,0x30000000,0xb000,0xb0008000,0x30008000,0xb000,0xb0008000,0x80003000
.long 0x2f9c28f2,0x2502afe7,0xb0008000,0x25022fe7,0x28f2af9c,0xafe7a502,0x80003000,0x2fe7a502
.long 0x2cb4ae79,0xaf9ca8f2,0x3000,0x2f9ca8f2,0xae79acb4,0xa8f22f9c,0x30008000,0xa8f2af9c
.long 0xacb4ae79,0xab442f21,0x30000000,0xab44af21,0xae792cb4,0x2f212b44,0xb000,0xaf212b44
.long 0xaf9c28f2,0x2e792cb4,0xb000,0xae792cb4,0x28f22f9c,0x2cb4ae79,0xb0008000,0x2cb42e79
.long 0x3000,0x2da8ada8,0xb0008000,0x2da82da8,0x30008000,0xada8ada8,0x80003000,0x2da8ada8
.long 0x2cb4ae79,0xacb4ae79,0xaf9c28f2,0x3000,0xae79acb4,0xae792cb4,0x28f22f9c,0x30008000
.long 0xaf9ca8f2,0xab442f21,0x2e792cb4,0x2da8ada8,0xa8f22f9c,0x2f212b44,0x2cb4ae79,0xada8ada8
.long 0x3000,0x30000000,0xb000,0xb0008000,0x30008000,0xb000,0xb0008000,0x80003000
.long 0x2f9ca8f2,0xab44af21,0xae792cb4,0x2da82da8,0xa8f2af9c,0xaf212b44,0x2cb42e79,0x2da8ada8
.long 0xacb4ae79,0xacb42e79,0x2f9c28f2,0xb000,0xae792cb4,0x2e792cb4,0x28f2af9c,0xb0008000
.long 0xacb42e79,0x2fe72502,0xa8f2af9c,0xada82da8,0x2e792cb4,0x2502afe7,0xaf9c28f2,0x2da82da8
.long 0x2f9c28f2,0xa8f2af9c,0xacb42e79,0x30000000,0x28f2af9c,0xaf9c28f2,0x2e792cb4,0xb000
.long 0xb000,0xada82da8,0x30000000,0xada8ada8,0xb0008000,0x2da82da8,0xb000,0xada82da8
.long 0x2f9c28f2,0x2cb4ae79,0xacb4ae79,0xaf9c28f2,0x28f2af9c,0xae79acb4,0xae792cb4,0x28f22f9c
.long 0xacb4ae79,0xaf212b44,0x28f22f9c,0x2fe7a502,0xae792cb4,0x2b442f21,0x2f9ca8f2,0xa502afe7
.long 0x3000,0x30000000,0xb000,0xb0008000,0x30008000,0xb000,0xb0008000,0x80003000
.long 0x2cb4ae79,0xaf21ab44,0xa8f22f9c,0x2fe72502,0xae79acb4,0xab442f21,0x2f9c28f2,0x2502afe7
.long 0xaf9c28f2,0x2cb42e79,0x2cb4ae79,0xaf9ca8f2,0x28f22f9c,0x2e79acb4,0xae79acb4,0xa8f22f9c
.long 0x2f9c28f2,0xa502afe7,0xae792cb4,0x2f212b44,0x28f2af9c,0xafe72502,0x2cb42e79,0x2b44af21
.long 0xacb4ae79,0xa8f22f9c,0x2f9ca8f2,0xae79acb4,0xae792cb4,0x2f9c28f2,0xa8f2af9c,0xacb42e79
.long 0x3000,0x2da8ada8,0xb0008000,0x2da82da8,0x30008000,0xada8ada8,0x80003000,0x2da8ada8
.long 0x3000,0x2f9c28f2,0x2cb4ae79,0xacb4ae79,0x30008000,0x28f2af9c,0xae79acb4,0xae792cb4
.long 0xb000,0xafe7a502,0xa8f22f9c,0x2f212b44,0xb0008000,0xa5022fe7,0x2f9c28f2,0x2b44af21
.long 0x3000,0x30000000,0xb000,0xb0008000,0x30008000,0xb000,0xb0008000,0x80003000
.long 0xb000,0xafe72502,0x28f22f9c,0x2f21ab44,0xb0008000,0x25022fe7,0x2f9ca8f2,0xab44af21
.long 0x3000,0x2f9ca8f2,0xacb4ae79,0xacb42e79,0x30008000,0xa8f2af9c,0xae792cb4,0x2e792cb4
.long 0xb000,0xaf212b44,0x2e792cb4,0x2502afe7,0xb0008000,0x2b442f21,0x2cb4ae79,0xafe7a502
.long 0x3000,0x2e79acb4,0xaf9ca8f2,0x28f22f9c,0x30008000,0xacb4ae79,0xa8f22f9c,0x2f9ca8f2
.long 0xb000,0xada82da8,0x30000000,0xada8ada8,0xb0008000,0x2da82da8,0xb000,0xada82da8
.long 0xaf9c28f2,0x3000,0x2f9c28f2,0x2cb4ae79,0x28f22f9c,0x30008000,0x28f2af9c,0xae79acb4
.long 0x2cb4ae79,0xada8ada8,0xae792cb4,0x2b442f21,0xae79acb4,0xada82da8,0x2cb42e79,0x2f21ab44
.long 0x3000,0x30000000,0xb000,0xb0008000,0x30008000,0xb000,0xb0008000,0x80003000
.long 0xacb4ae79,0xada82da8,0x2e792cb4,0x2b44af21,0xae792cb4,0x2da82da8,0x2cb4ae79,0xaf21ab44
.long 0x2f9c28f2,0xb000,0xaf9c28f2,0x2cb42e79,0x28f2af9c,0xb0008000,0x28f22f9c,0x2e79acb4
.long 0xaf9c28f2,0x2da82da8,0x28f2af9c,0xafe72502,0x28f22f9c,0x2da8ada8,0xaf9ca8f2,0x25022fe7
.long 0x2cb4ae79,0xb0008000,0x2cb42e79,0x28f2af9c,0xae79acb4,0x80003000,0x2e79acb4,0xaf9ca8f2
.long 0x3000,0x2da8ada8,0xb0008000,0x2da82da8,0x30008000,0xada8ada8,0x80003000,0x2da8ada8
.long 0xacb4ae79,0xaf9c28f2,0x3000,0x2f9c28f2,0xae792cb4,0x28f22f9c,0x30008000,0x28f2af9c
.long 0x2f9ca8f2,0xa502afe7,0xb0008000,0xa5022fe7,0xa8f2af9c,0xafe72502,0x80003000,0x2fe72502
.long 0x3000,0x30000000,0xb000,0xb0008000,0x30008000,0xb000,0xb0008000,0x80003000
.long 0xaf9ca8f2,0xa5022fe7,0x30000000,0xa502afe7,0xa8f22f9c,0x2fe72502,0xb000,0xafe72502
.long 0x2cb4ae79,0xaf9ca8f2,0x3000,0x2f9ca8f2,0xae79acb4,0xa8f22f9c,0x30008000,0xa8f2af9c
.long 0x2cb42e79,0x2b44af21,0xb0008000,0x2b442f21,0x2e79acb4,0xaf21ab44,0x80003000,0x2f21ab44
.long 0xaf9c28f2,0x2e792cb4,0xb000,0xae792cb4,0x28f22f9c,0x2cb4ae79,0xb0008000,0x2cb42e79
.long 0xb000,0xada82da8,0x30000000,0xada8ada8,0xb0008000,0x2da82da8,0xb000,0xada82da8
.long 0x2cb4ae79,0xacb4ae79,0xaf9c28f2,0x3000,0xae79acb4,0xae792cb4,0x28f22f9c,0x30008000
.long 0x2f9c28f2,0x2b44af21,0xae79acb4,0xada82da8,0x28f2af9c,0xaf21ab44,0xacb42e79,0x2da82da8
.long 0x3000,0x30000000,0xb000,0xb0008000,0x30008000,0xb000,0xb0008000,0x80003000
.long 0xaf9c28f2,0x2b442f21,0x2e79acb4,0xada8ada8,0x28f22f9c,0x2f21ab44,0xacb4ae79,0xada82da8
.long 0xacb4ae79,0xacb42e79,0x2f9c28f2,0xb000,0xae792cb4,0x2e792cb4,0x28f2af9c,0xb0008000
.long 0x2cb4ae79,0xafe7a502,0x28f22f9c,0x2da8ada8,0xae79acb4,0xa5022fe7,0x2f9ca8f2,0xada8ada8
.long 0x2f9c28f2,0xa8f2af9c,0xacb42e79,0x30000000,0x28f2af9c,0xaf9c28f2,0x2e792cb4,0xb000
.long 0x3000,0x2da8ada8,0xb0008000,0x2da82da8,0x30008000,0xada8ada8,0x80003000,0x2da8ada8
.long 0x2f9c28f2,0x2cb4ae79,0xacb4ae79,0xaf9c28f2,0x28f2af9c,0xae79acb4,0xae792cb4,0x28f22f9c
.long 0x2cb42e79,0x2f21ab44,0xa8f2af9c,0xafe72502,0x2e79acb4,0xab44af21,0xaf9c28f2,0x25022fe7
.long 0x3000,0x30000000,0xb000,0xb0008000,0x30008000,0xb000,0xb0008000,0x80003000
.long 0xacb42e79,0x2f212b44,0x28f2af9c,0xafe7a502,0x2e792cb4,0x2b44af21,0xaf9ca8f2,0xa5022fe7
.long 0xaf9c28f2,0x2cb42e79,0x2cb4ae79,0xaf9ca8f2,0x28f22f9c,0x2e79acb4,0xae79acb4,0xa8f22f9c
.long 0xaf9ca8f2,0x25022fe7,0x2e79acb4,0xaf21ab44,0xa8f22f9c,0x2fe7a502,0xacb4ae79,0xab442f21
.long 0xacb4ae79,0xa8f22f9c,0x2f9ca8f2,0xae79acb4,0xae792cb4,0x2f9c28f2,0xa8f2af9c,0xacb42e79
.long 0xb000,0xada82da8,0x30000000,0xada8ada8,0xb0008000,0x2da82da8,0xb000,0xada82da8
.long 0x0,0x0,0x0,0x0,0x0,0x0,0x0,0x0
.long 0x0,0x0,0x0,0x0,0x0,0x0,0x0,0x0
.long 0x0,0x0,0x0,0x0,0x0,0x0,0x0,0x0
.long 0x0,0x0,0x0,0x0,0x0,0x0,0x0,0x0
.long 0x0,0x0,0x0,0x0,0x0,0x0,0x0,0x0
.long 0x0,0x0,0x0,0x0,0x0,0x0,0x0,0x0
.long 0x0,0x0,0x0,0x0,0x0,0x0,0x0,0x0
.long 0x0,0x0,0x0,0x0,0x0,0x0,0x0,0x0
.long 0x0,0x0,0x0,0x0,0x0,0x0,0x0,0x0
.long 0x0,0x0,0x0,0x0,0x0,0x0,0x0,0x0
.long 0x0,0x0,0x0,0x0,0x0,0x0,0x0,0x0
.long 0x0,0x0,0x0,0x0,0x0,0x0,0x0,0x0
.long 0x0,0x0,0x0,0x0,0x0,0x0,0x0,0x0
.long 0x0,0x0,0x0,0x0,0x0,0x0,0x0,0x0
.long 0x0,0x0,0x0,0x0,0x0,0x0,0x0,0x0
.long 0x0,0x0,0x0,0x0,0x0,0x0,0x0,0x0
.long 0x3000,0xb000,0x3000,0xb000,0x30008000,0xb0008000,0x30008000,0xb0008000
.long 0x3000,0xa502afe7,0x28f22f9c,0xab44af21,0x30008000,0xafe72502,0x2f9ca8f2,0xaf212b44
.long 0x3000,0x2cb4ae79,0xaf9c28f2,0x2f9c28f2,0x30008000,0xae79acb4,0x28f22f9c,0x28f2af9c
.long 0x3000,0x2b44af21,0xae792cb4,0x2fe7a502,0x30008000,0xaf21ab44,0x2cb42e79,0xa502afe7
.long 0x3000,0x28f2af9c,0xacb42e79,0x2e79acb4,0x30008000,0xaf9ca8f2,0x2e792cb4,0xacb4ae79
.long 0x3000,0x2502afe7,0xa8f22f9c,0x2b44af21,0x30008000,0xafe7a502,0x2f9c28f2,0xaf21ab44
.long 0x3000,0xa8f2af9c,0x2cb42e79,0xae79acb4,0x30008000,0xaf9c28f2,0x2e79acb4,0xacb42e79
.long 0x3000,0xab44af21,0x2e792cb4,0xafe7a502,0x30008000,0xaf212b44,0x2cb4ae79,0xa5022fe7
.long 0x3000,0xb000,0x3000,0xb000,0x30008000,0xb0008000,0x30008000,0xb0008000
.long 0x2cb42e79,0xada8ada8,0x2e792cb4,0xaf21ab44,0x2e79acb4,0xada82da8,0x2cb4ae79,0xab442f21
.long 0xacb4ae79,0x3000,0x2cb4ae79,0xaf9c28f2,0xae792cb4,0x30008000,0xae79acb4,0x28f22f9c
.long 0xaf9ca8f2,0x2da82da8,0xa8f2af9c,0xa5022fe7,0xa8f22f9c,0x2da8ada8,0xaf9c28f2,0x2fe72502
.long 0xaf9c28f2,0x30000000,0xaf9ca8f2,0x2e792cb4,0x28f22f9c,0xb000,0xa8f22f9c,0x2cb4ae79
.long 0xacb42e79,0x2da8ada8,0xae792cb4,0x2f21ab44,0x2e792cb4,0xada8ada8,0x2cb42e79,0xab44af21
.long 0x2f9c28f2,0xb0008000,0x2f9ca8f2,0xae792cb4,0x28f2af9c,0x80003000,0xa8f2af9c,0x2cb42e79
.long 0x2f9ca8f2,0xada82da8,0x28f2af9c,0x25022fe7,0xa8f2af9c,0x2da82da8,0xaf9ca8f2,0x2fe7a502
.long 0x3000,0xb000,0x3000,0xb000,0x30008000,0xb0008000,0x30008000,0xb0008000
.long 0x2f9c28f2,0xafe7a502,0x30000000,0xafe72502,0x28f2af9c,0xa5022fe7,0xb000,0x25022fe7
.long 0x2f9c28f2,0xacb4ae79,0x3000,0x2cb4ae79,0x28f2af9c,0xae792cb4,0x30008000,0xae79acb4
.long 0x2cb4ae79,0xaf212b44,0x30000000,0xaf21ab44,0xae79acb4,0x2b442f21,0xb000,0xab442f21
.long 0xacb4ae79,0x28f22f9c,0xb000,0xa8f22f9c,0xae792cb4,0x2f9ca8f2,0xb0008000,0x2f9c28f2
.long 0xaf9c28f2,0x2fe7a502,0xb0008000,0x2fe72502,0x28f22f9c,0xa502afe7,0x80003000,0x2502afe7
.long 0x2cb4ae79,0xa8f22f9c,0xb000,0x28f22f9c,0xae79acb4,0x2f9c28f2,0xb0008000,0x2f9ca8f2
.long 0xacb4ae79,0x2f212b44,0xb0008000,0x2f21ab44,0xae792cb4,0x2b44af21,0x80003000,0xab44af21
.long 0x3000,0xb000,0x3000,0xb000,0x30008000,0xb0008000,0x30008000,0xb0008000
.long 0x2f9ca8f2,0xaf212b44,0x2e79acb4,0xada82da8,0xa8f2af9c,0x2b442f21,0xacb4ae79,0x2da82da8
.long 0xaf9c28f2,0x2f9c28f2,0xacb4ae79,0x3000,0x28f22f9c,0x28f2af9c,0xae792cb4,0x30008000
.long 0x2cb42e79,0xa502afe7,0xa8f22f9c,0x2da8ada8,0x2e79acb4,0xafe72502,0x2f9c28f2,0xada8ada8
.long 0x2cb4ae79,0xae792cb4,0x2f9ca8f2,0xb0008000,0xae79acb4,0x2cb42e79,0xa8f2af9c,0x80003000
.long 0xaf9ca8f2,0x2f212b44,0xae79acb4,0x2da82da8,0xa8f22f9c,0x2b44af21,0xacb42e79,0x2da8ada8
.long 0xacb4ae79,0x2e792cb4,0xaf9ca8f2,0x30000000,0xae792cb4,0x2cb4ae79,0xa8f22f9c,0xb000
.long 0xacb42e79,0x2502afe7,0x28f22f9c,0xada8ada8,0x2e792cb4,0xafe7a502,0x2f9ca8f2,0xada82da8
.long 0x3000,0xb000,0x3000,0xb000,0x30008000,0xb0008000,0x30008000,0xb0008000
.long 0x2cb4ae79,0xab442f21,0x28f2af9c,0xa5022fe7,0xae79acb4,0x2f212b44,0xaf9ca8f2,0x2fe72502
.long 0x2cb4ae79,0xaf9c28f2,0x2f9c28f2,0xacb4ae79,0xae79acb4,0x28f22f9c,0x28f2af9c,0xae792cb4
.long 0xaf9c28f2,0x2fe72502,0xae79acb4,0x2b442f21,0x28f22f9c,0x2502afe7,0xacb42e79,0x2f21ab44
.long 0x2f9c28f2,0xae79acb4,0x2cb42e79,0xa8f2af9c,0x28f2af9c,0xacb42e79,0x2e79acb4,0xaf9c28f2
.long 0xacb4ae79,0x2b442f21,0xa8f2af9c,0x25022fe7,0xae792cb4,0x2f21ab44,0xaf9c28f2,0x2fe7a502
.long 0xaf9c28f2,0x2e79acb4,0xacb42e79,0x28f2af9c,0x28f22f9c,0xacb4ae79,0x2e792cb4,0xaf9ca8f2
.long 0x2f9c28f2,0xafe72502,0x2e79acb4,0xab442f21,0x28f2af9c,0x25022fe7,0xacb4ae79,0x2f212b44
.long 0x3000,0xb000,0x3000,0xb000,0x30008000,0xb0008000,0x30008000,0xb0008000
.long 0xb000,0x25022fe7,0xa8f2af9c,0x2b442f21,0xb0008000,0x2fe7a502,0xaf9c28f2,0x2f21ab44
.long 0x3000,0x2cb4ae79,0xaf9c28f2,0x2f9c28f2,0x30008000,0xae79acb4,0x28f22f9c,0x28f2af9c
.long 0xb000,0xab442f21,0x2e79acb4,0xafe72502,0xb0008000,0x2f212b44,0xacb4ae79,0x25022fe7
.long 0x3000,0x28f2af9c,0xacb42e79,0x2e79acb4,0x30008000,0xaf9ca8f2,0x2e792cb4,0xacb4ae79
.long 0xb000,0xa5022fe7,0x28f2af9c,0xab442f21,0xb0008000,0x2fe72502,0xaf9ca8f2,0x2f212b44
.long 0x3000,0xa8f2af9c,0x2cb42e79,0xae79acb4,0x30008000,0xaf9c28f2,0x2e79acb4,0xacb42e79
.long 0xb000,0x2b442f21,0xae79acb4,0x2fe72502,0xb0008000,0x2f21ab44,0xacb42e79,0x2502afe7
.long 0x3000,0xb000,0x3000,0xb000,0x30008000,0xb0008000,0x30008000,0xb0008000
.long 0xacb4ae79,0x2da82da8,0xae79acb4,0x2f212b44,0xae792cb4,0x2da8ada8,0xacb42e79,0x2b44af21
.long 0xacb4ae79,0x3000,0x2cb4ae79,0xaf9c28f2,0xae792cb4,0x30008000,0xae79acb4,0x28f22f9c
.long 0x2f9c28f2,0xada8ada8,0x28f22f9c,0x2502afe7,0x28f2af9c,0xada82da8,0x2f9ca8f2,0xafe7a502
.long 0xaf9c28f2,0x30000000,0xaf9ca8f2,0x2e792cb4,0x28f22f9c,0xb000,0xa8f22f9c,0x2cb4ae79
.long 0x2cb4ae79,0xada82da8,0x2e79acb4,0xaf212b44,0xae79acb4,0x2da82da8,0xacb4ae79,0x2b442f21
.long 0x2f9c28f2,0xb0008000,0x2f9ca8f2,0xae792cb4,0x28f2af9c,0x80003000,0xa8f2af9c,0x2cb42e79
.long 0xaf9c28f2,0x2da8ada8,0xa8f22f9c,0xa502afe7,0x28f22f9c,0xada8ada8,0x2f9c28f2,0xafe72502
.long 0x3000,0xb000,0x3000,0xb000,0x30008000,0xb0008000,0x30008000,0xb0008000
.long 0xaf9ca8f2,0x2fe72502,0xb0008000,0x2fe7a502,0xa8f22f9c,0x2502afe7,0x80003000,0xa502afe7
.long 0x2f9c28f2,0xacb4ae79,0x3000,0x2cb4ae79,0x28f2af9c,0xae792cb4,0x30008000,0xae79acb4
.long 0xacb42e79,0x2f21ab44,0xb0008000,0x2f212b44,0x2e792cb4,0xab44af21,0x80003000,0x2b44af21
.long 0xacb4ae79,0x28f22f9c,0xb000,0xa8f22f9c,0xae792cb4,0x2f9ca8f2,0xb0008000,0x2f9c28f2
.long 0x2f9ca8f2,0xafe72502,0x30000000,0xafe7a502,0xa8f2af9c,0x25022fe7,0xb000,0xa5022fe7
.long 0x2cb4ae79,0xa8f22f9c,0xb000,0x28f22f9c,0xae79acb4,0x2f9c28f2,0xb0008000,0x2f9ca8f2
.long 0x2cb42e79,0xaf21ab44,0x30000000,0xaf212b44,0x2e79acb4,0xab442f21,0xb000,0x2b442f21
.long 0x3000,0xb000,0x3000,0xb000,0x30008000,0xb0008000,0x30008000,0xb0008000
.long 0xaf9c28f2,0x2f21ab44,0xae792cb4,0x2da8ada8,0x28f22f9c,0xab44af21,0x2cb42e79,0xada8ada8
.long 0xaf9c28f2,0x2f9c28f2,0xacb4ae79,0x3000,0x28f22f9c,0x28f2af9c,0xae792cb4,0x30008000
.long 0xacb4ae79,0x25022fe7,0x28f2af9c,0xada82da8,0xae792cb4,0x2fe7a502,0xaf9ca8f2,0x2da82da8
.long 0x2cb4ae79,0xae792cb4,0x2f9ca8f2,0xb0008000,0xae79acb4,0x2cb42e79,0xa8f2af9c,0x80003000
.long 0x2f9c28f2,0xaf21ab44,0x2e792cb4,0xada8ada8,0x28f2af9c,0xab442f21,0x2cb4ae79,0xada82da8
.long 0xacb4ae79,0x2e792cb4,0xaf9ca8f2,0x30000000,0xae792cb4,0x2cb4ae79,0xa8f22f9c,0xb000
.long 0x2cb4ae79,0xa5022fe7,0xa8f2af9c,0x2da82da8,0xae79acb4,0x2fe72502,0xaf9c28f2,0x2da8ada8
.long 0x3000,0xb000,0x3000,0xb000,0x30008000,0xb0008000,0x30008000,0xb0008000
.long 0xacb42e79,0x2b44af21,0xa8f22f9c,0x2502afe7,0x2e792cb4,0xaf21ab44,0x2f9c28f2,0xafe7a502
.long 0x2cb4ae79,0xaf9c28f2,0x2f9c28f2,0xacb4ae79,0xae79acb4,0x28f22f9c,0x28f2af9c,0xae792cb4
.long 0x2f9ca8f2,0xafe7a502,0x2e792cb4,0xab44af21,0xa8f2af9c,0xa5022fe7,0x2cb4ae79,0xaf212b44
.long 0x2f9c28f2,0xae79acb4,0x2cb42e79,0xa8f2af9c,0x28f2af9c,0xacb42e79,0x2e79acb4,0xaf9c28f2
.long 0x2cb42e79,0xab44af21,0x28f22f9c,0xa502afe7,0x2e79acb4,0xaf212b44,0x2f9ca8f2,0xafe72502
.long 0xaf9c28f2,0x2e79acb4,0xacb42e79,0x28f2af9c,0x28f22f9c,0xacb4ae79,0x2e792cb4,0xaf9ca8f2
.long 0xaf9ca8f2,0x2fe7a502,0xae792cb4,0x2b44af21,0xa8f22f9c,0xa502afe7,0x2cb42e79,0xaf21ab44
.long 0x0,0x0,0x0,0x0,0x0,0x0,0x0,0x0
.long 0x0,0x0,0x0,0x0,0x0,0x0,0x0,0x0
.long 0x0,0x0,0x0,0x0,0x0,0x0,0x0,0x0
.long 0x0,0x0,0x0,0x0,0x0,0x0,0x0,0x0
.long 0x0,0x0,0x0,0x0,0x0,0x0,0x0,0x0
.long 0x0,0x0,0x0,0x0,0x0,0x0,0x0,0x0
.long 0x0,0x0,0x0,0x0,0x0,0x0,0x0,0x0
.long 0x0,0x0,0x0,0x0,0x0,0x0,0x0,0x0
.long 0x0,0x0,0x0,0x0,0x0,0x0,0x0,0x0
.long 0x0,0x0,0x0,0x0,0x0,0x0,0x0,0x0
.long 0x0,0x0,0x0,0x0,0x0,0x0,0x0,0x0
.long 0x0,0x0,0x0,0x0,0x0,0x0,0x0,0x0
.long 0x0,0x0,0x0,0x0,0x0,0x0,0x0,0x0
.long 0x0,0x0,0x0,0x0,0x0,0x0,0x0,0x0
.long 0x0,0x0,0x0,0x0,0x0,0x0,0x0,0x0
.long 0x0,0x0,0x0,0x0,0x0,0x0,0x0,0x0
.long 0x38003800,0xb800b800,0x0,0x0,0xb8003800,0x3800b800,0x0,0x0
.long 0x38003800,0x38003800,0x0,0x0,0x38003800,0x38003800,0x0,0x0
.long 0x0,0x0,0x38003800,0xb800b800,0x0,0x0,0xb8003800,0x3800b800
.long 0x0,0x0,0x38003800,0x38003800,0x0,0x0,0x38003800,0x38003800
.long 0xb8003800,0x3800b800,0x0,0x0,0x38003800,0xb800b800,0x0,0x0
.long 0x38003800,0x38003800,0x0,0x0,0x38003800,0x38003800,0x0,0x0
.long 0x0,0x0,0xb8003800,0x3800b800,0x0,0x0,0x38003800,0xb800b800
.long 0x0,0x0,0x38003800,0x38003800,0x0,0x0,0x38003800,0x38003800
.long 0x39a8,0x8000b9a8,0x0,0x0,0x39a88000,0xb9a80000,0x0,0x0
.long 0x38003800,0x38003800,0x0,0x0,0xb800b800,0xb800b800,0x0,0x0
.long 0x0,0x0,0x39a8,0x8000b9a8,0x0,0x0,0x39a88000,0xb9a80000
.long 0x0,0x0,0x38003800,0x38003800,0x0,0x0,0xb800b800,0xb800b800
.long 0xb9a80000,0x39a88000,0x0,0x0,0x8000b9a8,0x39a8,0x0,0x0
.long 0x38003800,0x38003800,0x0,0x0,0xb800b800,0xb800b800,0x0,0x0
.long 0x0,0x0,0xb9a80000,0x39a88000,0x0,0x0,0x8000b9a8,0x39a8
.long 0x0,0x0,0x38003800,0x38003800,0x0,0x0,0xb800b800,0xb800b800
.long 0xb8003800,0x3800b800,0x0,0x0,0x38003800,0xb800b800,0x0,0x0
.long 0x38003800,0x38003800,0x0,0x0,0x38003800,0x38003800,0x0,0x0
.long 0x0,0x0,0xb8003800,0x3800b800,0x0,0x0,0x38003800,0xb800b800
.long 0x0,0x0,0x38003800,0x38003800,0x0,0x0,0x38003800,0x38003800
.long 0x38003800,0xb800b800,0x0,0x0,0xb8003800,0x3800b800,0x0,0x0
.long 0x38003800,0x38003800,0x0,0x0,0x38003800,0x38003800,0x0,0x0
.long 0x0,0x0,0x38003800,0xb800b800,0x0,0x0,0xb8003800,0x3800b800
.long 0x0,0x0,0x38003800,0x38003800,0x0,0x0,0x38003800,0x38003800
.long 0xb9a80000,0x39a88000,0x0,0x0,0x8000b9a8,0x39a8,0x0,0x0
.long 0x38003800,0x38003800,0x0,0x0,0xb800b800,0xb800b800,0x0,0x0
.long 0x0,0x0,0xb9a80000,0x39a88000,0x0,0x0,0x8000b9a8,0x39a8
.long 0x0,0x0,0x38003800,0x38003800,0x0,0x0,0xb800b800,0xb800b800
.long 0x39a8,0x8000b9a8,0x0,0x0,0x39a88000,0xb9a80000,0x0,0x0
.long 0x38003800,0x38003800,0x0,0x0,0xb800b800,0xb800b800,0x0,0x0
.long 0x0,0x0,0x39a8,0x8000b9a8,0x0,0x0,0x39a88000,0xb9a80000
.long 0x0,0x0,0x38003800,0x38003800,0x0,0x0,0xb800b800,0xb800b800
.long 0xb8003800,0xb8003800,0x0,0x0,0xb8003800,0xb8003800,0x0,0x0
.long 0x0,0x0,0xb8003800,0xb8003800,0x0,0x0,0xb8003800,0xb8003800
.long 0xb8003800,0xb8003800,0x0,0x0,0xb8003800,0xb8003800,0x0,0x0
.long 0x0,0x0,0xb8003800,0xb8003800,0x0,0x0,0xb8003800,0xb8003800
.long 0x0,0x0,0x0,0x0,0x0,0x0,0x0,0x0
.long 0x0,0x0,0x0,0x0,0x0,0x0,0x0,0x0
.long 0x0,0x0,0x0,0x0,0x0,0x0,0x0,0x0
.long 0x0,0x0,0x0,0x0,0x0,0x0,0x0,0x0
.long 0xb8003800,0xb8003800,0x0,0x0,0xb8003800,0xb8003800,0x0,0x0
.long 0x0,0x0,0xb8003800,0xb8003800,0x0,0x0,0xb8003800,0xb8003800
.long 0x3800b800,0x3800b800,0x0,0x0,0x3800b800,0x3800b800,0x0,0x0
.long 0x0,0x0,0x3800b800,0x3800b800,0x0,0x0,0x3800b800,0x3800b800
.long 0x0,0x0,0x0,0x0,0x0,0x0,0x0,0x0
.long 0x0,0x0,0x0,0x0,0x0,0x0,0x0,0x0
.long 0x0,0x0,0x0,0x0,0x0,0x0,0x0,0x0
.long 0x0,0x0,0x0,0x0,0x0,0x0,0x0,0x0
.long 0xb8003800,0xb8003800,0x0,0x0,0xb8003800,0xb8003800,0x0,0x0
.long 0x0,0x0,0xb8003800,0xb8003800,0x0,0x0,0xb8003800,0xb8003800
.long 0xb8003800,0xb8003800,0x0,0x0,0xb8003800,0xb8003800,0x0,0x0
.long 0x0,0x0,0xb8003800,0xb8003800,0x0,0x0,0xb8003800,0xb8003800
.long 0x0,0x0,0x0,0x0,0x0,0x0,0x0,0x0
.long 0x0,0x0,0x0,0x0,0x0,0x0,0x0,0x0
.long 0x0,0x0,0x0,0x0,0x0,0x0,0x0,0x0
.long 0x0,0x0,0x0,0x0,0x0,0x0,0x0,0x0
.long 0x3800b800,0x3800b800,0x0,0x0,0x3800b800,0x3800b800,0x0,0x0
.long 0x0,0x0,0x3800b800,0x3800b800,0x0,0x0,0x3800b800,0x3800b800
.long 0xb8003800,0xb8003800,0x0,0x0,0xb8003800,0xb8003800,0x0,0x0
.long 0x0,0x0,0xb8003800,0xb8003800,0x0,0x0,0xb8003800,0xb8003800
.long 0x0,0x0,0x0,0x0,0x0,0x0,0x0,0x0
.long 0x0,0x0,0x0,0x0,0x0,0x0,0x0,0x0
.long 0x0,0x0,0x0,0x0,0x0,0x0,0x0,0x0
.long 0x0,0x0,0x0,0x0,0x0,0x0,0x0,0x0
.long 0x0,0x0,0x0,0x0,0x0,0x0,0x0,0x0
.long 0x0,0x0,0x0,0x0,0x0,0x0,0x0,0x0
.long 0x0,0x0,0x0,0x0,0x0,0x0,0x0,0x0
.long 0x0,0x0,0x0,0x0,0x0,0x0,0x0,0x0
.long 0xb8003800,0xb8003800,0x0,0x0,0xb8003800,0xb8003800,0x0,0x0
.long 0x0,0x0,0xb8003800,0xb8003800,0x0,0x0,0xb8003800,0xb8003800
.long 0xb8003800,0xb8003800,0x0,0x0,0xb8003800,0xb8003800,0x0,0x0
.long 0x0,0x0,0xb8003800,0xb8003800,0x0,0x0,0xb8003800,0xb8003800
.long 0x0,0x0,0x0,0x0,0x0,0x0,0x0,0x0
.long 0x0,0x0,0x0,0x0,0x0,0x0,0x0,0x0
.long 0x0,0x0,0x0,0x0,0x0,0x0,0x0,0x0
.long 0x0,0x0,0x0,0x0,0x0,0x0,0x0,0x0
.long 0xb8003800,0xb8003800,0x0,0x0,0xb8003800,0xb8003800,0x0,0x0
.long 0x0,0x0,0xb8003800,0xb8003800,0x0,0x0,0xb8003800,0xb8003800
.long 0x3800b800,0x3800b800,0x0,0x0,0x3800b800,0x3800b800,0x0,0x0
.long 0x0,0x0,0x3800b800,0x3800b800,0x0,0x0,0x3800b800,0x3800b800
.long 0x0,0x0,0x0,0x0,0x0,0x0,0x0,0x0
.long 0x0,0x0,0x0,0x0,0x0,0x0,0x0,0x0
.long 0x0,0x0,0x0,0x0,0x0,0x0,0x0,0x0
.long 0x0,0x0,0x0,0x0,0x0,0x0,0x0,0x0
.long 0xb8003800,0xb8003800,0x0,0x0,0xb8003800,0xb8003800,0x0,0x0
.long 0x0,0x0,0xb8003800,0xb8003800,0x0,0x0,0xb8003800,0xb8003800
.long 0xb8003800,0xb8003800,0x0,0x0,0xb8003800,0xb8003800,0x0,0x0
.long 0x0,0x0,0xb8003800,0xb8003800,0x0,0x0,0xb8003800,0xb8003800
.long 0x0,0x0,0x0,0x0,0x0,0x0,0x0,0x0
.long 0x0,0x0,0x0,0x0,0x0,0x0,0x0,0x0
.long 0x0,0x0,0x0,0x0,0x0,0x0,0x0,0x0
.long 0x0,0x0,0x0,0x0,0x0,0x0,0x0,0x0
.long 0x3800b800,0x3800b800,0x0,0x0,0x3800b800,0x3800b800,0x0,0x0
.long 0x0,0x0,0x3800b800,0x3800b800,0x0,0x0,0x3800b800,0x3800b800
.long 0xb8003800,0xb8003800,0x0,0x0,0xb8003800,0xb8003800,0x0,0x0
.long 0x0,0x0,0xb8003800,0xb8003800,0x0,0x0,0xb8003800,0xb8003800
.long 0x38003800,0xb800b800,0x0,0x0,0xb8003800,0x3800b800,0x0,0x0
.long 0x38003800,0x38003800,0x0,0x0,0x38003800,0x38003800,0x0,0x0
.long 0xb8003800,0x3800b800,0x0,0x0,0x38003800,0xb800b800,0x0,0x0
.long 0x38003800,0x38003800,0x0,0x0,0x38003800,0x38003800,0x0,0x0
.long 0xb8003800,0xb8003800,0x0,0x0,0xb8003800,0xb8003800,0x0,0x0
.long 0xb8003800,0xb8003800,0x0,0x0,0xb8003800,0xb8003800,0x0,0x0
.long 0x0,0x0,0x0,0x0,0x0,0x0,0x0,0x0
.long 0x0,0x0,0x0,0x0,0x0,0x0,0x0,0x0
.long 0x39a8,0x8000b9a8,0x0,0x0,0x39a88000,0xb9a80000,0x0,0x0
.long 0x38003800,0x38003800,0x0,0x0,0xb800b800,0xb800b800,0x0,0x0
.long 0xb9a80000,0x39a88000,0x0,0x0,0x8000b9a8,0x39a8,0x0,0x0
.long 0x38003800,0x38003800,0x0,0x0,0xb800b800,0xb800b800,0x0,0x0
.long 0xb8003800,0xb8003800,0x0,0x0,0xb8003800,0xb8003800,0x0,0x0
.long 0x3800b800,0x3800b800,0x0,0x0,0x3800b800,0x3800b800,0x0,0x0
.long 0x0,0x0,0x0,0x0,0x0,0x0,0x0,0x0
.long 0x0,0x0,0x0,0x0,0x0,0x0,0x0,0x0
.long 0xb8003800,0x3800b800,0x0,0x0,0x38003800,0xb800b800,0x0,0x0
.long 0x38003800,0x38003800,0x0,0x0,0x38003800,0x38003800,0x0,0x0
.long 0x38003800,0xb800b800,0x0,0x0,0xb8003800,0x3800b800,0x0,0x0
.long 0x38003800,0x38003800,0x0,0x0,0x38003800,0x38003800,0x0,0x0
.long 0xb8003800,0xb8003800,0x0,0x0,0xb8003800,0xb8003800,0x0,0x0
.long 0xb8003800,0xb8003800,0x0,0x0,0xb8003800,0xb8003800,0x0,0x0
.long 0x0,0x0,0x0,0x0,0x0,0x0,0x0,0x0
.long 0x0,0x0,0x0,0x0,0x0,0x0,0x0,0x0
.long 0xb9a80000,0x39a88000,0x0,0x0,0x8000b9a8,0x39a8,0x0,0x0
.long 0x38003800,0x38003800,0x0,0x0,0xb800b800,0xb800b800,0x0,0x0
.long 0x39a8,0x8000b9a8,0x0,0x0,0x39a88000,0xb9a80000,0x0,0x0
.long 0x38003800,0x38003800,0x0,0x0,0xb800b800,0xb800b800,0x0,0x0
.long 0x3800b800,0x3800b800,0x0,0x0,0x3800b800,0x3800b800,0x0,0x0
.long 0xb8003800,0xb8003800,0x0,0x0,0xb8003800,0xb8003800,0x0,0x0
.long 0x0,0x0,0x0,0x0,0x0,0x0,0x0,0x0
.long 0x0,0x0,0x0,0x0,0x0,0x0,0x0,0x0
.long 0xb8003800,0x3800b800,0x0,0x0,0x38003800,0xb800b800,0x0,0x0
.long 0x38003800,0x38003800,0x0,0x0,0x38003800,0x38003800,0x0,0x0
.long 0x0,0x0,0x0,0x0,0x0,0x0,0x0,0x0
.long 0x0,0x0,0x0,0x0,0x0,0x0,0x0,0x0
.long 0x3800b800,0xb8003800,0x0,0x0,0xb800b800,0x38003800,0x0,0x0
.long 0xb800b800,0xb800b800,0x0,0x0,0xb800b800,0xb800b800,0x0,0x0
.long 0x0,0x0,0x0,0x0,0x0,0x0,0x0,0x0
.long 0x0,0x0,0x0,0x0,0x0,0x0,0x0,0x0
.long 0xb9a80000,0x39a80000,0x0,0x0,0x8000b9a8,0x39a8,0x0,0x0
.long 0x38003800,0x38003800,0x0,0x0,0xb800b800,0xb800b800,0x0,0x0
.long 0x0,0x0,0x0,0x0,0x0,0x0,0x0,0x0
.long 0x0,0x0,0x0,0x0,0x0,0x0,0x0,0x0
.long 0x39a88000,0xb9a80000,0x0,0x0,0x39a8,0x8000b9a8,0x0,0x0
.long 0xb800b800,0xb800b800,0x0,0x0,0x38003800,0x38003800,0x0,0x0
.long 0x0,0x0,0x0,0x0,0x0,0x0,0x0,0x0
.long 0x0,0x0,0x0,0x0,0x0,0x0,0x0,0x0
.long 0x3800b800,0xb8003800,0x0,0x0,0xb800b800,0x38003800,0x0,0x0
.long 0xb800b800,0xb800b800,0x0,0x0,0xb800b800,0xb800b800,0x0,0x0
.long 0x0,0x0,0x0,0x0,0x0,0x0,0x0,0x0
.long 0x0,0x0,0x0,0x0,0x0,0x0,0x0,0x0
.long 0xb8003800,0x3800b800,0x0,0x0,0x38003800,0xb800b800,0x0,0x0
.long 0x38003800,0x38003800,0x0,0x0,0x38003800,0x38003800,0x0,0x0
.long 0x0,0x0,0x0,0x0,0x0,0x0,0x0,0x0
.long 0x0,0x0,0x0,0x0,0x0,0x0,0x0,0x0
.long 0x39a88000,0xb9a80000,0x0,0x0,0x39a8,0x8000b9a8,0x0,0x0
.long 0xb800b800,0xb800b800,0x0,0x0,0x38003800,0x38003800,0x0,0x0
.long 0x0,0x0,0x0,0x0,0x0,0x0,0x0,0x0
.long 0x0,0x0,0x0,0x0,0x0,0x0,0x0,0x0
.long 0xb9a80000,0x39a80000,0x0,0x0,0x8000b9a8,0x39a8,0x0,0x0
.long 0x38003800,0x38003800,0x0,0x0,0xb800b800,0xb800b800,0x0,0x0
.long 0x0,0x0,0x0,0x0,0x0,0x0,0x0,0x0
.long 0x0,0x0,0x0,0x0,0x0,0x0,0x0,0x0
.long 0xb8003800,0xb8003800,0x0,0x0,0xb8003800,0xb8003800,0x0,0x0
.long 0x0,0x0,0x0,0x0,0x0,0x0,0x0,0x0
.long 0x3800b800,0x3800b800,0x0,0x0,0x3800b800,0x3800b800,0x0,0x0
.long 0x0,0x0,0x0,0x0,0x0,0x0,0x0,0x0
.long 0x0,0x0,0x0,0x0,0x0,0x0,0x0,0x0
.long 0x0,0x0,0x0,0x0,0x0,0x0,0x0,0x0
.long 0x0,0x0,0x0,0x0,0x0,0x0,0x0,0x0
.long 0x0,0x0,0x0,0x0,0x0,0x0,0x0,0x0
.long 0x3800b800,0x3800b800,0x0,0x0,0x3800b800,0x3800b800,0x0,0x0
.long 0x0,0x0,0x0,0x0,0x0,0x0,0x0,0x0
.long 0xb8003800,0xb8003800,0x0,0x0,0xb8003800,0xb8003800,0x0,0x0
.long 0x0,0x0,0x0,0x0,0x0,0x0,0x0,0x0
.long 0x0,0x0,0x0,0x0,0x0,0x0,0x0,0x0
.long 0x0,0x0,0x0,0x0,0x0,0x0,0x0,0x0
.long 0x0,0x0,0x0,0x0,0x0,0x0,0x0,0x0
.long 0x0,0x0,0x0,0x0,0x0,0x0,0x0,0x0
.long 0x3800b800,0x3800b800,0x0,0x0,0x3800b800,0x3800b800,0x0,0x0
.long 0x0,0x0,0x0,0x0,0x0,0x0,0x0,0x0
.long 0xb8003800,0xb8003800,0x0,0x0,0xb8003800,0xb8003800,0x0,0x0
.long 0x0,0x0,0x0,0x0,0x0,0x0,0x0,0x0
.long 0x0,0x0,0x0,0x0,0x0,0x0,0x0,0x0
.long 0x0,0x0,0x0,0x0,0x0,0x0,0x0,0x0
.long 0x0,0x0,0x0,0x0,0x0,0x0,0x0,0x0
.long 0x0,0x0,0x0,0x0,0x0,0x0,0x0,0x0
.long 0xb8003800,0xb8003800,0x0,0x0,0xb8003800,0xb8003800,0x0,0x0
.long 0x0,0x0,0x0,0x0,0x0,0x0,0x0,0x0
.long 0x3800b800,0x3800b800,0x0,0x0,0x3800b800,0x3800b800,0x0,0x0
.long 0x0,0x0,0x0,0x0,0x0,0x0,0x0,0x0
.long 0x0,0x0,0x0,0x0,0x0,0x0,0x0,0x0
.long 0x0,0x0,0x0,0x0,0x0,0x0,0x0,0x0
.long 0x0,0x0,0x0,0x0,0x0,0x0,0x0,0x0
.long 0x0,0x0,0x0,0x0,0x0,0x0,0x0,0x0
.long 0x48004800,0x4800,0x4800,0x4800,0x48004800,0x48000000,0xc800,0x48000000
.long 0x48004800,0xc800,0x4800,0xc800,0x48004800,0xc8008000,0xc800,0xc8008000
.long 0x48004800,0xc8008000,0xc800,0xc8008000,0x48004800,0xc800,0x4800,0xc800
.long 0x48004800,0x48000000,0xc800,0x48000000,0x48004800,0x4800,0x4800,0x4800
.long 0x0,0x0,0x0,0x0,0x0,0x0,0x0,0x0
.long 0x0,0x0,0x0,0x0,0x0,0x0,0x0,0x0
.long 0x0,0x0,0x0,0x0,0x0,0x0,0x0,0x0
.long 0x0,0x0,0x0,0x0,0x0,0x0,0x0,0x0
.long 0x4800,0x4800,0x4800,0x4800,0x4800,0x48000000,0xc800,0x48000000
.long 0x4800,0xc800,0x4800,0xc800,0x4800,0xc8008000,0xc800,0xc8008000
.long 0x4800,0xc8008000,0xc800,0xc8008000,0x4800,0xc800,0x4800,0xc800
.long 0x4800,0x48000000,0xc800,0x48000000,0x4800,0x4800,0x4800,0x4800
.long 0x0,0x0,0x0,0x0,0x0,0x0,0x0,0x0
.long 0x0,0x0,0x0,0x0,0x0,0x0,0x0,0x0
.long 0x0,0x0,0x0,0x0,0x0,0x0,0x0,0x0
.long 0x0,0x0,0x0,0x0,0x0,0x0,0x0,0x0
.long 0x0,0x0,0x0,0x0,0x0,0x0,0x0,0x0
.long 0x0,0x0,0x0,0x0,0x0,0x0,0x0,0x0
.long 0x0,0x0,0x0,0x0,0x0,0x0,0x0,0x0
.long 0x0,0x0,0x0,0x0,0x0,0x0,0x0,0x0
.long 0x48004800,0x4800,0x4800,0x4800,0x48004800,0x48000000,0xc800,0x48000000
.long 0x48004800,0xc800,0x4800,0xc800,0x48004800,0xc8008000,0xc800,0xc8008000
.long 0x48004800,0xc8008000,0xc800,0xc8008000,0x48004800,0xc800,0x4800,0xc800
.long 0x48004800,0x48000000,0xc800,0x48000000,0x48004800,0x4800,0x4800,0x4800
.long 0x0,0x0,0x0,0x0,0x0,0x0,0x0,0x0
.long 0x0,0x0,0x0,0x0,0x0,0x0,0x0,0x0
.long 0x0,0x0,0x0,0x0,0x0,0x0,0x0,0x0
.long 0x0,0x0,0x0,0x0,0x0,0x0,0x0,0x0
.long 0x4800,0x4800,0x4800,0x4800,0x4800,0x48000000,0xc800,0x48000000
.long 0x4800,0xc800,0x4800,0xc800,0x4800,0xc8008000,0xc800,0xc8008000
.long 0x4800,0xc8008000,0xc800,0xc8008000,0x4800,0xc800,0x4800,0xc800
.long 0x4800,0x48000000,0xc800,0x48000000,0x4800,0x4800,0x4800,0x4800
.long 0xc8004800,0x421f4764,0x45a845a8,0xc764421f,0xc8004800,0x4764c21f,0xc5a8c5a8,0x421f4764
.long 0xc8004800,0xc21fc764,0x45a845a8,0x4764c21f,0xc8004800,0xc764421f,0xc5a8c5a8,0xc21fc764
.long 0xc8004800,0xc764421f,0xc5a8c5a8,0xc21fc764,0xc8004800,0xc21fc764,0x45a845a8,0x4764c21f
.long 0xc8004800,0x4764c21f,0xc5a8c5a8,0x421f4764,0xc8004800,0x421f4764,0x45a845a8,0xc764421f
.long 0x0,0x0,0x0,0x0,0x0,0x0,0x0,0x0
.long 0x0,0x0,0x0,0x0,0x0,0x0,0x0,0x0
.long 0x0,0x0,0x0,0x0,0x0,0x0,0x0,0x0
.long 0x0,0x0,0x0,0x0,0x0,0x0,0x0,0x0
.long 0x48000000,0x4764c21f,0x45a8c5a8,0xc21fc764,0x48000000,0xc21fc764,0xc5a845a8,0xc764421f
.long 0x48000000,0xc764421f,0x45a8c5a8,0x421f4764,0x48000000,0x421f4764,0xc5a845a8,0x4764c21f
.long 0x48000000,0x421f4764,0xc5a845a8,0x4764c21f,0x48000000,0xc764421f,0x45a8c5a8,0x421f4764
.long 0x48000000,0xc21fc764,0xc5a845a8,0xc764421f,0x48000000,0x4764c21f,0x45a8c5a8,0xc21fc764
.long 0x0,0x0,0x0,0x0,0x0,0x0,0x0,0x0
.long 0x0,0x0,0x0,0x0,0x0,0x0,0x0,0x0
.long 0x0,0x0,0x0,0x0,0x0,0x0,0x0,0x0
.long 0x0,0x0,0x0,0x0,0x0,0x0,0x0,0x0
.long 0x0,0x0,0x0,0x0,0x0,0x0,0x0,0x0
.long 0x0,0x0,0x0,0x0,0x0,0x0,0x0,0x0
.long 0x0,0x0,0x0,0x0,0x0,0x0,0x0,0x0
.long 0x0,0x0,0x0,0x0,0x0,0x0,0x0,0x0
.long 0xc8004800,0x421f4764,0x45a845a8,0xc764421f,0xc8004800,0x4764c21f,0xc5a8c5a8,0x421f4764
.long 0xc8004800,0xc21fc764,0x45a845a8,0x4764c21f,0xc8004800,0xc764421f,0xc5a8c5a8,0xc21fc764
.long 0xc8004800,0xc764421f,0xc5a8c5a8,0xc21fc764,0xc8004800,0xc21fc764,0x45a845a8,0x4764c21f
.long 0xc8004800,0x4764c21f,0xc5a8c5a8,0x421f4764,0xc8004800,0x421f4764,0x45a845a8,0xc764421f
.long 0x0,0x0,0x0,0x0,0x0,0x0,0x0,0x0
.long 0x0,0x0,0x0,0x0,0x0,0x0,0x0,0x0
.long 0x0,0x0,0x0,0x0,0x0,0x0,0x0,0x0
.long 0x0,0x0,0x0,0x0,0x0,0x0,0x0,0x0
.long 0x48000000,0x4764c21f,0x45a8c5a8,0xc21fc764,0x48000000,0xc21fc764,0xc5a845a8,0xc764421f
.long 0x48000000,0xc764421f,0x45a8c5a8,0x421f4764,0x48000000,0x421f4764,0xc5a845a8,0x4764c21f
.long 0x48000000,0x421f4764,0xc5a845a8,0x4764c21f,0x48000000,0xc764421f,0x45a8c5a8,0x421f4764
.long 0x48000000,0xc21fc764,0xc5a845a8,0xc764421f,0x48000000,0x4764c21f,0x45a8c5a8,0xc21fc764
.long 0x48004800,0x45a845a8,0x48000000,0xc5a8c5a8,0x48004800,0x45a8c5a8,0xc8008000,0xc5a845a8
.long 0x48004800,0xc5a8c5a8,0x48000000,0x45a845a8,0x48004800,0xc5a845a8,0xc8008000,0x45a8c5a8
.long 0x48004800,0xc5a845a8,0xc8008000,0x45a8c5a8,0x48004800,0xc5a8c5a8,0x48000000,0x45a845a8
.long 0x48004800,0x45a8c5a8,0xc8008000,0xc5a845a8,0x48004800,0x45a845a8,0x48000000,0xc5a8c5a8
.long 0x0,0x0,0x0,0x0,0x0,0x0,0x0,0x0
.long 0x0,0x0,0x0,0x0,0x0,0x0,0x0,0x0
.long 0x0,0x0,0x0,0x0,0x0,0x0,0x0,0x0
.long 0x0,0x0,0x0,0x0,0x0,0x0,0x0,0x0
.long 0xc800,0xc5a8c5a8,0xc8008000,0x45a845a8,0xc800,0xc5a845a8,0x48000000,0x45a8c5a8
.long 0xc800,0x45a845a8,0xc8008000,0xc5a8c5a8,0xc800,0x45a8c5a8,0x48000000,0xc5a845a8
.long 0xc800,0x45a8c5a8,0x48000000,0xc5a845a8,0xc800,0x45a845a8,0xc8008000,0xc5a8c5a8
.long 0xc800,0xc5a845a8,0x48000000,0x45a8c5a8,0xc800,0xc5a8c5a8,0xc8008000,0x45a845a8
.long 0x0,0x0,0x0,0x0,0x0,0x0,0x0,0x0
.long 0x0,0x0,0x0,0x0,0x0,0x0,0x0,0x0
.long 0x0,0x0,0x0,0x0,0x0,0x0,0x0,0x0
.long 0x0,0x0,0x0,0x0,0x0,0x0,0x0,0x0
.long 0x0,0x0,0x0,0x0,0x0,0x0,0x0,0x0
.long 0x0,0x0,0x0,0x0,0x0,0x0,0x0,0x0
.long 0x0,0x0,0x0,0x0,0x0,0x0,0x0,0x0
.long 0x0,0x0,0x0,0x0,0x0,0x0,0x0,0x0
.long 0x48004800,0x45a845a8,0x48000000,0xc5a8c5a8,0x48004800,0x45a8c5a8,0xc8008000,0xc5a845a8
.long 0x48004800,0xc5a8c5a8,0x48000000,0x45a845a8,0x48004800,0xc5a845a8,0xc8008000,0x45a8c5a8
.long 0x48004800,0xc5a845a8,0xc8008000,0x45a8c5a8,0x48004800,0xc5a8c5a8,0x48000000,0x45a845a8
.long 0x48004800,0x45a8c5a8,0xc8008000,0xc5a845a8,0x48004800,0x45a845a8,0x48000000,0xc5a8c5a8
.long 0x0,0x0,0x0,0x0,0x0,0x0,0x0,0x0
.long 0x0,0x0,0x0,0x0,0x0,0x0,0x0,0x0
.long 0x0,0x0,0x0,0x0,0x0,0x0,0x0,0x0
.long 0x0,0x0,0x0,0x0,0x0,0x0,0x0,0x0
.long 0xc800,0xc5a8c5a8,0xc8008000,0x45a845a8,0xc800,0xc5a845a8,0x48000000,0x45a8c5a8
.long 0xc800,0x45a845a8,0xc8008000,0xc5a8c5a8,0xc800,0x45a8c5a8,0x48000000,0xc5a845a8
.long 0xc800,0x45a8c5a8,0x48000000,0xc5a845a8,0xc800,0x45a845a8,0xc8008000,0xc5a8c5a8
.long 0xc800,0xc5a845a8,0x48000000,0x45a8c5a8,0xc800,0xc5a8c5a8,0xc8008000,0x45a845a8
.long 0xc8004800,0x4764421f,0x45a8c5a8,0x421fc764,0xc8004800,0x421fc764,0xc5a845a8,0xc764c21f
.long 0xc8004800,0xc764c21f,0x45a8c5a8,0xc21f4764,0xc8004800,0xc21f4764,0xc5a845a8,0x4764421f
.long 0xc8004800,0xc21f4764,0xc5a845a8,0x4764421f,0xc8004800,0xc764c21f,0x45a8c5a8,0xc21f4764
.long 0xc8004800,0x421fc764,0xc5a845a8,0xc764c21f,0xc8004800,0x4764421f,0x45a8c5a8,0x421fc764
.long 0x0,0x0,0x0,0x0,0x0,0x0,0x0,0x0
.long 0x0,0x0,0x0,0x0,0x0,0x0,0x0,0x0
.long 0x0,0x0,0x0,0x0,0x0,0x0,0x0,0x0
.long 0x0,0x0,0x0,0x0,0x0,0x0,0x0,0x0
.long 0xc8008000,0xc21f4764,0x45a845a8,0xc764c21f,0xc8008000,0x4764421f,0xc5a8c5a8,0xc21f4764
.long 0xc8008000,0x421fc764,0x45a845a8,0x4764421f,0xc8008000,0xc764c21f,0xc5a8c5a8,0x421fc764
.long 0xc8008000,0xc764c21f,0xc5a8c5a8,0x421fc764,0xc8008000,0x421fc764,0x45a845a8,0x4764421f
.long 0xc8008000,0x4764421f,0xc5a8c5a8,0xc21f4764,0xc8008000,0xc21f4764,0x45a845a8,0xc764c21f
.long 0x0,0x0,0x0,0x0,0x0,0x0,0x0,0x0
.long 0x0,0x0,0x0,0x0,0x0,0x0,0x0,0x0
.long 0x0,0x0,0x0,0x0,0x0,0x0,0x0,0x0
.long 0x0,0x0,0x0,0x0,0x0,0x0,0x0,0x0
.long 0x0,0x0,0x0,0x0,0x0,0x0,0x0,0x0
.long 0x0,0x0,0x0,0x0,0x0,0x0,0x0,0x0
.long 0x0,0x0,0x0,0x0,0x0,0x0,0x0,0x0
.long 0x0,0x0,0x0,0x0,0x0,0x0,0x0,0x0
.long 0xc8004800,0x4764421f,0x45a8c5a8,0x421fc764,0xc8004800,0x421fc764,0xc5a845a8,0xc764c21f
.long 0xc8004800,0xc764c21f,0x45a8c5a8,0xc21f4764,0xc8004800,0xc21f4764,0xc5a845a8,0x4764421f
.long 0xc8004800,0xc21f4764,0xc5a845a8,0x4764421f,0xc8004800,0xc764c21f,0x45a8c5a8,0xc21f4764
.long 0xc8004800,0x421fc764,0xc5a845a8,0xc764c21f,0xc8004800,0x4764421f,0x45a8c5a8,0x421fc764
.long 0x0,0x0,0x0,0x0,0x0,0x0,0x0,0x0
.long 0x0,0x0,0x0,0x0,0x0,0x0,0x0,0x0
.long 0x0,0x0,0x0,0x0,0x0,0x0,0x0,0x0
.long 0x0,0x0,0x0,0x0,0x0,0x0,0x0,0x0
.long 0xc8008000,0xc21f4764,0x45a845a8,0xc764c21f,0xc8008000,0x4764421f,0xc5a8c5a8,0xc21f4764
.long 0xc8008000,0x421fc764,0x45a845a8,0x4764421f,0xc8008000,0xc764c21f,0xc5a8c5a8,0x421fc764
.long 0xc8008000,0xc764c21f,0xc5a8c5a8,0x421fc764,0xc8008000,0x421fc764,0x45a845a8,0x4764421f
.long 0xc8008000,0x4764421f,0xc5a8c5a8,0xc21f4764,0xc8008000,0xc21f4764,0x45a845a8,0xc764c21f
.long 0x48004800,0x4800,0x4800,0x4800,0x48004800,0x48000000,0xc800,0x48000000
.long 0x48004800,0xc800,0x4800,0xc800,0x48004800,0xc8008000,0xc800,0xc8008000
.long 0x48004800,0xc8008000,0xc800,0xc8008000,0x48004800,0xc800,0x4800,0xc800
.long 0x48004800,0x48000000,0xc800,0x48000000,0x48004800,0x4800,0x4800,0x4800
.long 0x0,0x0,0x0,0x0,0x0,0x0,0x0,0x0
.long 0x0,0x0,0x0,0x0,0x0,0x0,0x0,0x0
.long 0x0,0x0,0x0,0x0,0x0,0x0,0x0,0x0
.long 0x0,0x0,0x0,0x0,0x0,0x0,0x0,0x0
.long 0x4800,0x4800,0x4800,0x4800,0x4800,0x48000000,0xc800,0x48000000
.long 0x4800,0xc800,0x4800,0xc800,0x4800,0xc8008000,0xc800,0xc8008000
.long 0x4800,0xc8008000,0xc800,0xc8008000,0x4800,0xc800,0x4800,0xc800
.long 0x4800,0x48000000,0xc800,0x48000000,0x4800,0x4800,0x4800,0x4800
.long 0x0,0x0,0x0,0x0,0x0,0x0,0x0,0x0
.long 0x0,0x0,0x0,0x0,0x0,0x0,0x0,0x0
.long 0x0,0x0,0x0,0x0,0x0,0x0,0x0,0x0
.long 0x0,0x0,0x0,0x0,0x0,0x0,0x0,0x0
.long 0x0,0x0,0x0,0x0,0x0,0x0,0x0,0x0
.long 0x0,0x0,0x0,0x0,0x0,0x0,0x0,0x0
.long 0x0,0x0,0x0,0x0,0x0,0x0,0x0,0x0
.long 0x0,0x0,0x0,0x0,0x0,0x0,0x0,0x0
.long 0xc8004800,0xc21f4764,0xc5a845a8,0x4764421f,0xc8004800,0xc764c21f,0x45a8c5a8,0xc21f4764
.long 0xc8004800,0x421fc764,0xc5a845a8,0xc764c21f,0xc8004800,0x4764421f,0x45a8c5a8,0x421fc764
.long 0xc8004800,0x4764421f,0x45a8c5a8,0x421fc764,0xc8004800,0x421fc764,0xc5a845a8,0xc764c21f
.long 0xc8004800,0xc764c21f,0x45a8c5a8,0xc21f4764,0xc8004800,0xc21f4764,0xc5a845a8,0x4764421f
.long 0x0,0x0,0x0,0x0,0x0,0x0,0x0,0x0
.long 0x0,0x0,0x0,0x0,0x0,0x0,0x0,0x0
.long 0x0,0x0,0x0,0x0,0x0,0x0,0x0,0x0
.long 0x0,0x0,0x0,0x0,0x0,0x0,0x0,0x0
.long 0xc8008000,0xc764c21f,0xc5a8c5a8,0x421fc764,0xc8008000,0x421fc764,0x45a845a8,0x4764421f
.long 0xc8008000,0x4764421f,0xc5a8c5a8,0xc21f4764,0xc8008000,0xc21f4764,0x45a845a8,0xc764c21f
.long 0xc8008000,0xc21f4764,0x45a845a8,0xc764c21f,0xc8008000,0x4764421f,0xc5a8c5a8,0xc21f4764
.long 0xc8008000,0x421fc764,0x45a845a8,0x4764421f,0xc8008000,0xc764c21f,0xc5a8c5a8,0x421fc764
.long 0xc8004800,0x421f4764,0x45a845a8,0xc764421f,0xc8004800,0x4764c21f,0xc5a8c5a8,0x421f4764
.long 0xc8004800,0xc21fc764,0x45a845a8,0x4764c21f,0xc8004800,0xc764421f,0xc5a8c5a8,0xc21fc764
.long 0xc8004800,0xc764421f,0xc5a8c5a8,0xc21fc764,0xc8004800,0xc21fc764,0x45a845a8,0x4764c21f
.long 0xc8004800,0x4764c21f,0xc5a8c5a8,0x421f4764,0xc8004800,0x421f4764,0x45a845a8,0xc764421f
.long 0x0,0x0,0x0,0x0,0x0,0x0,0x0,0x0
.long 0x0,0x0,0x0,0x0,0x0,0x0,0x0,0x0
.long 0x0,0x0,0x0,0x0,0x0,0x0,0x0,0x0
.long 0x0,0x0,0x0,0x0,0x0,0x0,0x0,0x0
.long 0x48000000,0x4764c21f,0x45a8c5a8,0xc21fc764,0x48000000,0xc21fc764,0xc5a845a8,0xc764421f
.long 0x48000000,0xc764421f,0x45a8c5a8,0x421f4764,0x48000000,0x421f4764,0xc5a845a8,0x4764c21f
.long 0x48000000,0x421f4764,0xc5a845a8,0x4764c21f,0x48000000,0xc764421f,0x45a8c5a8,0x421f4764
.long 0x48000000,0xc21fc764,0xc5a845a8,0xc764421f,0x48000000,0x4764c21f,0x45a8c5a8,0xc21fc764
.long 0x0,0x0,0x0,0x0,0x0,0x0,0x0,0x0
.long 0x0,0x0,0x0,0x0,0x0,0x0,0x0,0x0
.long 0x0,0x0,0x0,0x0,0x0,0x0,0x0,0x0
.long 0x0,0x0,0x0,0x0,0x0,0x0,0x0,0x0
.long 0x0,0x0,0x0,0x0,0x0,0x0,0x0,0x0
.long 0x0,0x0,0x0,0x0,0x0,0x0,0x0,0x0
.long 0x0,0x0,0x0,0x0,0x0,0x0,0x0,0x0
.long 0x0,0x0,0x0,0x0,0x0,0x0,0x0,0x0
.long 0x48004800,0xc5a845a8,0xc8008000,0x45a8c5a8,0x48004800,0xc5a8c5a8,0x48000000,0x45a845a8
.long 0x48004800,0x45a8c5a8,0xc8008000,0xc5a845a8,0x48004800,0x45a845a8,0x48000000,0xc5a8c5a8
.long 0x48004800,0x45a845a8,0x48000000,0xc5a8c5a8,0x48004800,0x45a8c5a8,0xc8008000,0xc5a845a8
.long 0x48004800,0xc5a8c5a8,0x48000000,0x45a845a8,0x48004800,0xc5a845a8,0xc8008000,0x45a8c5a8
.long 0x0,0x0,0x0,0x0,0x0,0x0,0x0,0x0
.long 0x0,0x0,0x0,0x0,0x0,0x0,0x0,0x0
.long 0x0,0x0,0x0,0x0,0x0,0x0,0x0,0x0
.long 0x0,0x0,0x0,0x0,0x0,0x0,0x0,0x0
.long 0xc800,0x45a8c5a8,0x48000000,0xc5a845a8,0xc800,0x45a845a8,0xc8008000,0xc5a8c5a8
.long 0xc800,0xc5a845a8,0x48000000,0x45a8c5a8,0xc800,0xc5a8c5a8,0xc8008000,0x45a845a8
.long 0xc800,0xc5a8c5a8,0xc8008000,0x45a845a8,0xc800,0xc5a845a8,0x48000000,0x45a8c5a8
.long 0xc800,0x45a845a8,0xc8008000,0xc5a8c5a8,0xc800,0x45a8c5a8,0x48000000,0xc5a845a8
.long 0x48004800,0x45a845a8,0x48000000,0xc5a8c5a8,0x48004800,0x45a8c5a8,0xc8008000,0xc5a845a8
.long 0x48004800,0xc5a8c5a8,0x48000000,0x45a845a8,0x48004800,0xc5a845a8,0xc8008000,0x45a8c5a8
.long 0x48004800,0xc5a845a8,0xc8008000,0x45a8c5a8,0x48004800,0xc5a8c5a8,0x48000000,0x45a845a8
.long 0x48004800,0x45a8c5a8,0xc8008000,0xc5a845a8,0x48004800,0x45a845a8,0x48000000,0xc5a8c5a8
.long 0x0,0x0,0x0,0x0,0x0,0x0,0x0,0x0
.long 0x0,0x0,0x0,0x0,0x0,0x0,0x0,0x0
.long 0x0,0x0,0x0,0x0,0x0,0x0,0x0,0x0
.long 0x0,0x0,0x0,0x0,0x0,0x0,0x0,0x0
.long 0xc800,0xc5a8c5a8,0xc8008000,0x45a845a8,0xc800,0xc5a845a8,0x48000000,0x45a8c5a8
.long 0xc800,0x45a845a8,0xc8008000,0xc5a8c5a8,0xc800,0x45a8c5a8,0x48000000,0xc5a845a8
.long 0xc800,0x45a8c5a8,0x48000000,0xc5a845a8,0xc800,0x45a845a8,0xc8008000,0xc5a8c5a8
.long 0xc800,0xc5a845a8,0x48000000,0x45a8c5a8,0xc800,0xc5a8c5a8,0xc8008000,0x45a845a8
.long 0x0,0x0,0x0,0x0,0x0,0x0,0x0,0x0
.long 0x0,0x0,0x0,0x0,0x0,0x0,0x0,0x0
.long 0x0,0x0,0x0,0x0,0x0,0x0,0x0,0x0
.long 0x0,0x0,0x0,0x0,0x0,0x0,0x0,0x0
.long 0x0,0x0,0x0,0x0,0x0,0x0,0x0,0x0
.long 0x0,0x0,0x0,0x0,0x0,0x0,0x0,0x0
.long 0x0,0x0,0x0,0x0,0x0,0x0,0x0,0x0
.long 0x0,0x0,0x0,0x0,0x0,0x0,0x0,0x0
.long 0xc8004800,0xc764421f,0xc5a8c5a8,0xc21fc764,0xc8004800,0xc21fc764,0x45a845a8,0x4764c21f
.long 0xc8004800,0x4764c21f,0xc5a8c5a8,0x421f4764,0xc8004800,0x421f4764,0x45a845a8,0xc764421f
.long 0xc8004800,0x421f4764,0x45a845a8,0xc764421f,0xc8004800,0x4764c21f,0xc5a8c5a8,0x421f4764
.long 0xc8004800,0xc21fc764,0x45a845a8,0x4764c21f,0xc8004800,0xc764421f,0xc5a8c5a8,0xc21fc764
.long 0x0,0x0,0x0,0x0,0x0,0x0,0x0,0x0
.long 0x0,0x0,0x0,0x0,0x0,0x0,0x0,0x0
.long 0x0,0x0,0x0,0x0,0x0,0x0,0x0,0x0
.long 0x0,0x0,0x0,0x0,0x0,0x0,0x0,0x0
.long 0x48000000,0x421f4764,0xc5a845a8,0x4764c21f,0x48000000,0xc764421f,0x45a8c5a8,0x421f4764
.long 0x48000000,0xc21fc764,0xc5a845a8,0xc764421f,0x48000000,0x4764c21f,0x45a8c5a8,0xc21fc764
.long 0x48000000,0x4764c21f,0x45a8c5a8,0xc21fc764,0x48000000,0xc21fc764,0xc5a845a8,0xc764421f
.long 0x48000000,0xc764421f,0x45a8c5a8,0x421f4764,0x48000000,0x421f4764,0xc5a845a8,0x4764c21f
.long 0xc8004800,0x4764421f,0x45a8c5a8,0x421fc764,0xc8004800,0x421fc764,0xc5a845a8,0xc764c21f
.long 0xc8004800,0xc764c21f,0x45a8c5a8,0xc21f4764,0xc8004800,0xc21f4764,0xc5a845a8,0x4764421f
.long 0xc8004800,0xc21f4764,0xc5a845a8,0x4764421f,0xc8004800,0xc764c21f,0x45a8c5a8,0xc21f4764
.long 0xc8004800,0x421fc764,0xc5a845a8,0xc764c21f,0xc8004800,0x4764421f,0x45a8c5a8,0x421fc764
.long 0x0,0x0,0x0,0x0,0x0,0x0,0x0,0x0
.long 0x0,0x0,0x0,0x0,0x0,0x0,0x0,0x0
.long 0x0,0x0,0x0,0x0,0x0,0x0,0x0,0x0
.long 0x0,0x0,0x0,0x0,0x0,0x0,0x0,0x0
.long 0xc8008000,0xc21f4764,0x45a845a8,0xc764c21f,0xc8008000,0x4764421f,0xc5a8c5a8,0xc21f4764
.long 0xc8008000,0x421fc764,0x45a845a8,0x4764421f,0xc8008000,0xc764c21f,0xc5a8c5a8,0x421fc764
.long 0xc8008000,0xc764c21f,0xc5a8c5a8,0x421fc764,0xc8008000,0x421fc764,0x45a845a8,0x4764421f
.long 0xc8008000,0x4764421f,0xc5a8c5a8,0xc21f4764,0xc8008000,0xc21f4764,0x45a845a8,0xc764c21f
.long 0x0,0x0,0x0,0x0,0x0,0x0,0x0,0x0
.long 0x0,0x0,0x0,0x0,0x0,0x0,0x0,0x0
.long 0x0,0x0,0x0,0x0,0x0,0x0,0x0,0x0
.long 0x0,0x0,0x0,0x0,0x0,0x0,0x0,0x0
.long 0x0,0x0,0x0,0x0,0x0,0x0,0x0,0x0
.long 0x0,0x0,0x0,0x0,0x0,0x0,0x0,0x0
.long 0x0,0x0,0x0,0x0,0x0,0x0,0x0,0x0
.long 0x0,0x0,0x0,0x0,0x0,0x0,0x0,0x0
.long 0x48004800,0xc8008000,0xc800,0xc8008000,0x48004800,0xc800,0x4800,0xc800
.long 0x48004800,0x48000000,0xc800,0x48000000,0x48004800,0x4800,0x4800,0x4800
.long 0x48004800,0x4800,0x4800,0x4800,0x48004800,0x48000000,0xc800,0x48000000
.long 0x48004800,0xc800,0x4800,0xc800,0x48004800,0xc8008000,0xc800,0xc8008000
.long 0x0,0x0,0x0,0x0,0x0,0x0,0x0,0x0
.long 0x0,0x0,0x0,0x0,0x0,0x0,0x0,0x0
.long 0x0,0x0,0x0,0x0,0x0,0x0,0x0,0x0
.long 0x0,0x0,0x0,0x0,0x0,0x0,0x0,0x0
.long 0x4800,0xc8008000,0xc800,0xc8008000,0x4800,0xc800,0x4800,0xc800
.long 0x4800,0x48000000,0xc800,0x48000000,0x4800,0x4800,0x4800,0x4800
.long 0x4800,0x4800,0x4800,0x4800,0x4800,0x48000000,0xc800,0x48000000
.long 0x4800,0xc800,0x4800,0xc800,0x4800,0xc8008000,0xc800,0xc8008000
.long 0xc8004800,0x421f4764,0x45a845a8,0xc764421f,0xc8004800,0x4764c21f,0xc5a8c5a8,0x421f4764
.long 0xc8004800,0xc21fc764,0x45a845a8,0x4764c21f,0xc8004800,0xc764421f,0xc5a8c5a8,0xc21fc764
.long 0xc8004800,0xc764421f,0xc5a8c5a8,0xc21fc764,0xc8004800,0xc21fc764,0x45a845a8,0x4764c21f
.long 0xc8004800,0x4764c21f,0xc5a8c5a8,0x421f4764,0xc8004800,0x421f4764,0x45a845a8,0xc764421f
.long 0x0,0x0,0x0,0x0,0x0,0x0,0x0,0x0
.long 0x0,0x0,0x0,0x0,0x0,0x0,0x0,0x0
.long 0x0,0x0,0x0,0x0,0x0,0x0,0x0,0x0
.long 0x0,0x0,0x0,0x0,0x0,0x0,0x0,0x0
.long 0x48000000,0x4764c21f,0x45a8c5a8,0xc21fc764,0x48000000,0xc21fc764,0xc5a845a8,0xc764421f
.long 0x48000000,0xc764421f,0x45a8c5a8,0x421f4764,0x48000000,0x421f4764,0xc5a845a8,0x4764c21f
.long 0x48000000,0x421f4764,0xc5a845a8,0x4764c21f,0x48000000,0xc764421f,0x45a8c5a8,0x421f4764
.long 0x48000000,0xc21fc764,0xc5a845a8,0xc764421f,0x48000000,0x4764c21f,0x45a8c5a8,0xc21fc764
.long 0x0,0x0,0x0,0x0,0x0,0x0,0x0,0x0
.long 0x0,0x0,0x0,0x0,0x0,0x0,0x0,0x0
.long 0x0,0x0,0x0,0x0,0x0,0x0,0x0,0x0
.long 0x0,0x0,0x0,0x0,0x0,0x0,0x0,0x0
.long 0x0,0x0,0x0,0x0,0x0,0x0,0x0,0x0
.long 0x0,0x0,0x0,0x0,0x0,0x0,0x0,0x0
.long 0x0,0x0,0x0,0x0,0x0,0x0,0x0,0x0
.long 0x0,0x0,0x0,0x0,0x0,0x0,0x0,0x0
.long 0xc8004800,0xc21f4764,0xc5a845a8,0x4764421f,0xc8004800,0xc764c21f,0x45a8c5a8,0xc21f4764
.long 0xc8004800,0x421fc764,0xc5a845a8,0xc764c21f,0xc8004800,0x4764421f,0x45a8c5a8,0x421fc764
.long 0xc8004800,0x4764421f,0x45a8c5a8,0x421fc764,0xc8004800,0x421fc764,0xc5a845a8,0xc764c21f
.long 0xc8004800,0xc764c21f,0x45a8c5a8,0xc21f4764,0xc8004800,0xc21f4764,0xc5a845a8,0x4764421f
.long 0x0,0x0,0x0,0x0,0x0,0x0,0x0,0x0
.long 0x0,0x0,0x0,0x0,0x0,0x0,0x0,0x0
.long 0x0,0x0,0x0,0x0,0x0,0x0,0x0,0x0
.long 0x0,0x0,0x0,0x0,0x0,0x0,0x0,0x0
.long 0xc8008000,0xc764c21f,0xc5a8c5a8,0x421fc764,0xc8008000,0x421fc764,0x45a845a8,0x4764421f
.long 0xc8008000,0x4764421f,0xc5a8c5a8,0xc21f4764,0xc8008000,0xc21f4764,0x45a845a8,0xc764c21f
.long 0xc8008000,0xc21f4764,0x45a845a8,0xc764c21f,0xc8008000,0x4764421f,0xc5a8c5a8,0xc21f4764
.long 0xc8008000,0x421fc764,0x45a845a8,0x4764421f,0xc8008000,0xc764c21f,0xc5a8c5a8,0x421fc764
.long 0x48004800,0x4800,0x4800,0x4800,0x48004800,0x48000000,0xc800,0x48000000
.long 0x48004800,0xc800,0x4800,0xc800,0x48004800,0xc8008000,0xc800,0xc8008000
.long 0x48004800,0xc5a845a8,0xc8008000,0x45a8c5a8,0x48004800,0xc5a8c5a8,0x48000000,0x45a845a8
.long 0x48004800,0x45a8c5a8,0xc8008000,0xc5a845a8,0x48004800,0x45a845a8,0x48000000,0xc5a8c5a8
.long 0x0,0x0,0x0,0x0,0x0,0x0,0x0,0x0
.long 0x0,0x0,0x0,0x0,0x0,0x0,0x0,0x0
.long 0x0,0x0,0x0,0x0,0x0,0x0,0x0,0x0
.long 0x0,0x0,0x0,0x0,0x0,0x0,0x0,0x0
.long 0x4800,0x4800,0x4800,0x4800,0x4800,0x48000000,0xc800,0x48000000
.long 0x4800,0xc800,0x4800,0xc800,0x4800,0xc8008000,0xc800,0xc8008000
.long 0xc800,0x45a8c5a8,0x48000000,0xc5a845a8,0xc800,0x45a845a8,0xc8008000,0xc5a8c5a8
.long 0xc800,0xc5a845a8,0x48000000,0x45a8c5a8,0xc800,0xc5a8c5a8,0xc8008000,0x45a845a8
.long 0x0,0x0,0x0,0x0,0x0,0x0,0x0,0x0
.long 0x0,0x0,0x0,0x0,0x0,0x0,0x0,0x0
.long 0x0,0x0,0x0,0x0,0x0,0x0,0x0,0x0
.long 0x0,0x0,0x0,0x0,0x0,0x0,0x0,0x0
.long 0x0,0x0,0x0,0x0,0x0,0x0,0x0,0x0
.long 0x0,0x0,0x0,0x0,0x0,0x0,0x0,0x0
.long 0x0,0x0,0x0,0x0,0x0,0x0,0x0,0x0
.long 0x0,0x0,0x0,0x0,0x0,0x0,0x0,0x0
.long 0x48004800,0x4800,0x4800,0x4800,0x48004800,0xc8008000,0xc800,0xc8008000
.long 0x48004800,0xc800,0x4800,0xc800,0x48004800,0x48000000,0xc800,0x48000000
.long 0x48004800,0x45a845a8,0x48000000,0xc5a8c5a8,0x48004800,0x45a8c5a8,0xc8008000,0xc5a845a8
.long 0x48004800,0xc5a8c5a8,0x48000000,0x45a845a8,0x48004800,0xc5a845a8,0xc8008000,0x45a8c5a8
.long 0x0,0x0,0x0,0x0,0x0,0x0,0x0,0x0
.long 0x0,0x0,0x0,0x0,0x0,0x0,0x0,0x0
.long 0x0,0x0,0x0,0x0,0x0,0x0,0x0,0x0
.long 0x0,0x0,0x0,0x0,0x0,0x0,0x0,0x0
.long 0x4800,0x4800,0x4800,0x4800,0x4800,0xc8008000,0xc800,0xc8008000
.long 0x4800,0xc800,0x4800,0xc800,0x4800,0x48000000,0xc800,0x48000000
.long 0xc800,0xc5a8c5a8,0xc8008000,0x45a845a8,0xc800,0xc5a845a8,0x48000000,0x45a8c5a8
.long 0xc800,0x45a845a8,0xc8008000,0xc5a8c5a8,0xc800,0x45a8c5a8,0x48000000,0xc5a845a8
.long 0x28c0020,0x1e001920,0x11980518,0x0,0x2dc0050,0x1e501950,0x16980a18,0x0
.long 0x32c00a0,0x1ea019a0,0x11e80568,0x0,0x37c00f0,0x1ef019f0,0x16e80a68,0x0
.long 0x3cc0140,0x1f401a40,0x123805b8,0x0,0x41c0190,0x1f901a90,0x17380ab8,0x0
.long 0x46c01e0,0x1fe01ae0,0x12880608,0x0,0x4bc0230,0x20301b30,0x17880b08,0x0
.long 0x50c0280,0x20801b80,0x12d80658,0x0,0x55c02d0,0x20d01bd0,0x17d80b58,0x0
.long 0x5ac0320,0x21201c20,0x132806a8,0x0,0x5fc0370,0x21701c70,0x18280ba8,0x0
.long 0x64c03c0,0x21c01cc0,0x137806f8,0x0,0x69c0410,0x22101d10,0x18780bf8,0x0
.long 0x6ec0460,0x22601d60,0x13c80748,0x0,0x73c04b0,0x22b01db0,0x18c80c48,0x0
.long 0x78c0500,0x20bc1900,0x142407a4,0x0,0x7dc0550,0x206c256c,0xf2402a4,0x0
.long 0x82c05a0,0x201c251c,0x13d40754,0x0,0x87c05f0,0x1fcc24cc,0xed40254,0x0
.long 0x8cc0640,0x1f7c247c,0x13840704,0x0,0x91c0690,0x1f2c242c,0xe840204,0x0
.long 0x96c06e0,0x1edc23dc,0x133406b4,0x0,0x9bc0730,0x1e8c238c,0xe3401b4,0x0
.long 0xa0c0780,0x1e3c233c,0x12e40664,0x0,0xa5c07d0,0x1dec22ec,0xde40164,0x0
.long 0xaac0820,0x1d9c229c,0x12940614,0x0,0xafc0870,0x1d4c224c,0xd940114,0x0
.long 0xb4c08c0,0x1cfc21fc,0x124405c4,0x0,0xb9c0910,0x1cac21ac,0xd4400c4,0x0
.long 0xbec0960,0x1c5c215c,0x11f40574,0x0,0xc3c09b0,0x1c0c210c,0xcf40074,0x0
.long 0xa300000,0x208c1b8c,0x20a41e18,0x0,0x9e00c6c,0x20dc1bdc,0x1ba42318,0x0
.long 0x9900c1c,0x212c1c2c,0x20541e68,0x0,0x9400bcc,0x217c1c7c,0x1b542368,0x0
.long 0x8f00b7c,0x21cc1ccc,0x20041eb8,0x0,0x8a00b2c,0x221c1d1c,0x1b0423b8,0x0
.long 0x8500adc,0x226c1d6c,0x1fb41f08,0x0,0x8000a8c,0x22bc1dbc,0x1ab42408,0x0
.long 0x7b00a3c,0x230c1e0c,0x1f641f58,0x0,0x76009ec,0x235c1e5c,0x1a642458,0x0
.long 0x710099c,0x23ac1eac,0x1f141fa8,0x0,0x6c0094c,0x23fc1efc,0x1a1424a8,0x0
.long 0x67008fc,0x244c1f4c,0x1ec41ff8,0x0,0x62008ac,0x249c1f9c,0x19c424f8,0x0
.long 0x5d0085c,0x24ec1fec,0x1e742048,0x0,0x580080c,0x253c203c,0x19742548,0x0
.long 0x53007bc,0x1e302330,0x26902690,0x0,0x4e0076c,0x1de022e0,0x26942694,0x0
.long 0x490071c,0x1d902290,0x26982698,0x0,0x44006cc,0x1d402240,0x269c269c,0x0
.long 0x3f0067c,0x1cf021f0,0x26a026a0,0x0,0x3a0062c,0x1ca021a0,0x26a426a4,0x0
.long 0x35005dc,0x1c502150,0x26a826a8,0x0,0x300058c,0x1c002100,0x26ac26ac,0x0
.long 0x2b0053c,0x1bb020b0,0x26b026b0,0x0,0x26004ec,0x1b602060,0x26b426b4,0x0
.long 0x210049c,0x1b102010,0x26b826b8,0x0,0x1c0044c,0x1ac01fc0,0x26bc26bc,0x0
.long 0x17003fc,0x1a701f70,0x26c026c0,0x0,0x12003ac,0x1a201f20,0x26c426c4,0x0
.long 0xd0035c,0x19d01ed0,0x26c826c8,0x0,0x80030c,0x19801e80,0x26cc26cc,0x0
.long 0x100a00,0x1b842300,0x14180798,0x0,0x600a50,0x1bd42350,0xc9c001c,0x0
.long 0xb00aa0,0x1c2423a0,0x146807e8,0x0,0x1000af0,0x1c7423f0,0xcec006c,0x0
.long 0x1500b40,0x1cc42440,0x14b80838,0x0,0x1a00b90,0x1d142490,0xd3c00bc,0x0
.long 0x1f00be0,0x1d6424e0,0x15080888,0x0,0x2400c30,0x1db42530,0xd8c010c,0x0
.long 0x2900004,0x1e041904,0x155808d8,0x0,0x2e00054,0x1e541954,0xddc015c,0x0
.long 0x33000a4,0x1ea419a4,0x15a80928,0x0,0x38000f4,0x1ef419f4,0xe2c01ac,0x0
.long 0x3d00144,0x1f441a44,0x15f80978,0x0,0x4200194,0x1f941a94,0xe7c01fc,0x0
.long 0x47001e4,0x1fe41ae4,0x164809c8,0x0,0x4c00234,0x20341b34,0xecc024c,0x0
.long 0x5100284,0x23381bbc,0x11a40524,0x0,0x56002d4,0x22e81b6c,0xca40024,0x0
.long 0x5b00324,0x22981b1c,0x115404d4,0x0,0x6000374,0x22481acc,0x18d00c50,0x0
.long 0x65003c4,0x21f81a7c,0x11040484,0x0,0x6a00414,0x21a81a2c,0x18800c00,0x0
.long 0x6f00464,0x215819dc,0x10b40434,0x0,0x74004b4,0x2108198c,0x18300bb0,0x0
.long 0x7900504,0x20b8193c,0x106403e4,0x0,0x7e00554,0x20682568,0x17e00b60,0x0
.long 0x83005a4,0x20182518,0x10140394,0x0,0x88005f4,0x1fc824c8,0x17900b10,0x0
.long 0x8d00644,0x1f782478,0xfc40344,0x0,0x9200694,0x1f282428,0x17400ac0,0x0
.long 0x97006e4,0x1ed823d8,0xf7402f4,0x0,0x9c00734,0x1e882388,0x16f00a70,0x0
.long 0x3002bc,0x1e101910,0x1e242098,0x0,0xc5c026c,0x1e601960,0x1924191c,0x0
.long 0xc0c021c,0x1eb019b0,0x1dd420e8,0x0,0xbbc01cc,0x1f001a00,0x2550196c,0x0
.long 0xb6c017c,0x1f501a50,0x1d842138,0x0,0xb1c012c,0x1fa01aa0,0x250019bc,0x0
.long 0xacc00dc,0x1ff01af0,0x1d342188,0x0,0xa7c008c,0x20401b40,0x24b01a0c,0x0
.long 0xa2c003c,0x20901b90,0x1ce421d8,0x0,0x9dc0c68,0x20e01be0,0x24601a5c,0x0
.long 0x98c0c18,0x21301c30,0x1c942228,0x0,0x93c0bc8,0x21801c80,0x24101aac,0x0
.long 0x8ec0b78,0x21d01cd0,0x1c442278,0x0,0x89c0b28,0x22201d20,0x23c01afc,0x0
.long 0x84c0ad8,0x22701d70,0x1bf422c8,0x0,0x7fc0a88,0x22c01dc0,0x23701b4c,0x0
.long 0x7ac0a38,0x20ac1930,0x26902690,0x0,0x75c09e8,0x205c255c,0x26942694,0x0
.long 0x70c0998,0x200c250c,0x26982698,0x0,0x6bc0948,0x1fbc24bc,0x269c269c,0x0
.long 0x66c08f8,0x1f6c246c,0x26a026a0,0x0,0x61c08a8,0x1f1c241c,0x26a426a4,0x0
.long 0x5cc0858,0x1ecc23cc,0x26a826a8,0x0,0x57c0808,0x1e7c237c,0x26ac26ac,0x0
.long 0x52c07b8,0x1e2c232c,0x26b026b0,0x0,0x4dc0768,0x1ddc22dc,0x26b426b4,0x0
.long 0x48c0718,0x1d8c228c,0x26b826b8,0x0,0x43c06c8,0x1d3c223c,0x26bc26bc,0x0
.long 0x3ec0678,0x1cec21ec,0x26c026c0,0x0,0x39c0628,0x1c9c219c,0x26c426c4,0x0
.long 0x34c05d8,0x1c4c214c,0x26c826c8,0x0,0x2fc0588,0x1bfc20fc,0x26cc26cc,0x0
.long 0xa100784,0x19082084,0xf1c029c,0x0,0xa6007d4,0x195820d4,0x141c079c,0x0
.long 0xab00824,0x19a82124,0xf6c02ec,0x0,0xb000874,0x19f82174,0x146c07ec,0x0
.long 0xb5008c4,0x1a4821c4,0xfbc033c,0x0,0xba00914,0x1a982214,0x14bc083c,0x0
.long 0xbf00964,0x1ae82264,0x100c038c,0x0,0xc4009b4,0x1b3822b4,0x150c088c,0x0
.long 0x140a04,0x1b882304,0x105c03dc,0x0,0x640a54,0x1bd82354,0x155c08dc,0x0
.long 0xb40aa4,0x1c2823a4,0x10ac042c,0x0,0x1040af4,0x1c7823f4,0x15ac092c,0x0
.long 0x1540b44,0x1cc82444,0x10fc047c,0x0,0x1a40b94,0x1d182494,0x15fc097c,0x0
.long 0x1f40be4,0x1d6824e4,0x114c04cc,0x0,0x2440c34,0x1db82534,0x164c09cc,0x0
.long 0x2940008,0x19381e38,0x16a00a20,0x0,0x2e40058,0x25641de8,0x11a00520,0x0
.long 0x33400a8,0x25141d98,0x165009d0,0x0,0x38400f8,0x24c41d48,0x115004d0,0x0
.long 0x3d40148,0x24741cf8,0x16000980,0x0,0x4240198,0x24241ca8,0x11000480,0x0
.long 0x47401e8,0x23d41c58,0x15b00930,0x0,0x4c40238,0x23841c08,0x10b00430,0x0
.long 0x5140288,0x23341bb8,0x156008e0,0x0,0x56402d8,0x22e41b68,0x106003e0,0x0
.long 0x5b40328,0x22941b18,0x15100890,0x0,0x6040378,0x22441ac8,0x10100390,0x0
.long 0x65403c8,0x21f41a78,0x14c00840,0x0,0x6a40418,0x21a41a28,0xfc00340,0x0
.long 0x6f40468,0x215419d8,0x147007f0,0x0,0x74404b8,0x21041988,0xf7002f0,0x0
.long 0x2ac0538,0x1b942310,0x23201b9c,0x0,0x25c04e8,0x1be42360,0x1e20209c,0x0
.long 0x20c0498,0x1c3423b0,0x22d01bec,0x0,0x1bc0448,0x1c842400,0x1dd020ec,0x0
.long 0x16c03f8,0x1cd42450,0x22801c3c,0x0,0x11c03a8,0x1d2424a0,0x1d80213c,0x0
.long 0xcc0358,0x1d7424f0,0x22301c8c,0x0,0x7c0308,0x1dc42540,0x1d30218c,0x0
.long 0x2c02b8,0x1e141914,0x21e01cdc,0x0,0xc580268,0x1e641964,0x1ce021dc,0x0
.long 0xc080218,0x1eb419b4,0x21901d2c,0x0,0xbb801c8,0x1f041a04,0x1c90222c,0x0
.long 0xb680178,0x1f541a54,0x21401d7c,0x0,0xb180128,0x1fa41aa4,0x1c40227c,0x0
.long 0xac800d8,0x1ff41af4,0x20f01dcc,0x0,0xa780088,0x20441b44,0x1bf022cc,0x0
.long 0xa280038,0x23281bac,0x26902690,0x0,0x9d80c64,0x22d81b5c,0x26942694,0x0
.long 0x9880c14,0x22881b0c,0x26982698,0x0,0x9380bc4,0x22381abc,0x269c269c,0x0
.long 0x8e80b74,0x21e81a6c,0x26a026a0,0x0,0x8980b24,0x21981a1c,0x26a426a4,0x0
.long 0x8480ad4,0x214819cc,0x26a826a8,0x0,0x7f80a84,0x20f8197c,0x26ac26ac,0x0
.long 0x7a80a34,0x20a8192c,0x26b026b0,0x0,0x75809e4,0x20582558,0x26b426b4,0x0
.long 0x7080994,0x20082508,0x26b826b8,0x0,0x6b80944,0x1fb824b8,0x26bc26bc,0x0
.long 0x66808f4,0x1f682468,0x26c026c0,0x0,0x61808a4,0x1f182418,0x26c426c4,0x0
.long 0x5c80854,0x1ec823c8,0x26c826c8,0x0,0x5780804,0x1e782378,0x26cc26cc,0x0
.long 0x7940508,0x23081e08,0x119c051c,0x0,0x7e40558,0x23581e58,0x169c0a1c,0x0
.long 0x83405a8,0x23a81ea8,0x11ec056c,0x0,0x88405f8,0x23f81ef8,0x16ec0a6c,0x0
.long 0x8d40648,0x24481f48,0x123c05bc,0x0,0x9240698,0x24981f98,0x173c0abc,0x0
.long 0x97406e8,0x24e81fe8,0x128c060c,0x0,0x9c40738,0x25382038,0x178c0b0c,0x0
.long 0xa140788,0x190c2088,0x12dc065c,0x0,0xa6407d8,0x195c20d8,0x17dc0b5c,0x0
.long 0xab40828,0x19ac2128,0x132c06ac,0x0,0xb040878,0x19fc2178,0x182c0bac,0x0
.long 0xb5408c8,0x1a4c21c8,0x137c06fc,0x0,0xba40918,0x1a9c2218,0x187c0bfc,0x0
.long 0xbf40968,0x1aec2268,0x13cc074c,0x0,0xc4409b8,0x1b3c22b8,0x18cc0c4c,0x0
.long 0x180a08,0x1bb420b4,0x142007a0,0x0,0x680a58,0x1b642064,0xf2002a0,0x0
.long 0xb80aa8,0x1b142014,0x13d00750,0x0,0x1080af8,0x1ac41fc4,0xed00250,0x0
.long 0x1580b48,0x1a741f74,0x13800700,0x0,0x1a80b98,0x1a241f24,0xe800200,0x0
.long 0x1f80be8,0x19d41ed4,0x133006b0,0x0,0x2480c38,0x19841e84,0xe3001b0,0x0
.long 0x298000c,0x19341e34,0x12e00660,0x0,0x2e8005c,0x25601de4,0xde00160,0x0
.long 0x33800ac,0x25101d94,0x12900610,0x0,0x38800fc,0x24c01d44,0xd900110,0x0
.long 0x3d8014c,0x24701cf4,0x124005c0,0x0,0x428019c,0x24201ca4,0xd4000c0,0x0
.long 0x47801ec,0x23d01c54,0x11f00570,0x0,0x4c8023c,0x23801c04,0xcf00070,0x0
.long 0x52807b4,0x19182094,0x20a01e1c,0x0,0x4d80764,0x196820e4,0x1ba0231c,0x0
.long 0x4880714,0x19b82134,0x20501e6c,0x0,0x43806c4,0x1a082184,0x1b50236c,0x0
.long 0x3e80674,0x1a5821d4,0x20001ebc,0x0,0x3980624,0x1aa82224,0x1b0023bc,0x0
.long 0x34805d4,0x1af82274,0x1fb01f0c,0x0,0x2f80584,0x1b4822c4,0x1ab0240c,0x0
.long 0x2a80534,0x1b982314,0x1f601f5c,0x0,0x25804e4,0x1be82364,0x1a60245c,0x0
.long 0x2080494,0x1c3823b4,0x1f101fac,0x0,0x1b80444,0x1c882404,0x1a1024ac,0x0
.long 0x16803f4,0x1cd82454,0x1ec01ffc,0x0,0x11803a4,0x1d2824a4,0x19c024fc,0x0
.long 0xc80354,0x1d7824f4,0x1e70204c,0x0,0x780304,0x1dc82544,0x1970254c,0x0
.long 0x2802b4,0x19281e28,0x26902690,0x0,0xc540264,0x25541dd8,0x26942694,0x0
.long 0xc040214,0x25041d88,0x26982698,0x0,0xbb401c4,0x24b41d38,0x269c269c,0x0
.long 0xb640174,0x24641ce8,0x26a026a0,0x0,0xb140124,0x24141c98,0x26a426a4,0x0
.long 0xac400d4,0x23c41c48,0x26a826a8,0x0,0xa740084,0x23741bf8,0x26ac26ac,0x0
.long 0xa240034,0x23241ba8,0x26b026b0,0x0,0x9d40c60,0x22d41b58,0x26b426b4,0x0
.long 0x9840c10,0x22841b08,0x26b826b8,0x0,0x9340bc0,0x22341ab8,0x26bc26bc,0x0
.long 0x8e40b70,0x21e41a68,0x26c026c0,0x0,0x8940b20,0x21941a18,0x26c426c4,0x0
.long 0x8440ad0,0x214419c8,0x26c826c8,0x0,0x7f40a80,0x20f41978,0x26cc26cc,0x0
.long 0x28c0000,0x1e001900,0x11980518,0x0,0x2dc0050,0x1e501950,0x16980a18,0x0
.long 0x32c00a0,0x1ea019a0,0x11e80568,0x0,0x37c00f0,0x1ef019f0,0x16e80a68,0x0
.long 0x3cc0140,0x1f401a40,0x123805b8,0x0,0x41c0190,0x1f901a90,0x17380ab8,0x0
.long 0x46c01e0,0x1fe01ae0,0x12880608,0x0,0x4bc0230,0x20301b30,0x17880b08,0x0
.long 0x50c0280,0x20801b80,0x12d80658,0x0,0x55c02d0,0x20d01bd0,0x17d80b58,0x0
.long 0x5ac0320,0x21201c20,0x132806a8,0x0,0x5fc0370,0x21701c70,0x18280ba8,0x0
.long 0x64c03c0,0x21c01cc0,0x137806f8,0x0,0x69c0410,0x22101d10,0x18780bf8,0x0
.long 0x6ec0460,0x22601d60,0x13c80748,0x0,0x73c04b0,0x22b01db0,0x18c80c48,0x0
.long 0x78c0500,0x1e201920,0x11b80538,0x0,0x7dc0550,0x1e701970,0x16b80a38,0x0
.long 0x82c05a0,0x1ec019c0,0x12080588,0x0,0x87c05f0,0x1f101a10,0x17080a88,0x0
.long 0x8cc0640,0x1f601a60,0x125805d8,0x0,0x91c0690,0x1fb01ab0,0x17580ad8,0x0
.long 0x96c06e0,0x20001b00,0x12a80628,0x0,0x9bc0730,0x20501b50,0x17a80b28,0x0
.long 0xa0c0780,0x20a01ba0,0x12f80678,0x0,0xa5c07d0,0x20f01bf0,0x17f80b78,0x0
.long 0xaac0820,0x21401c40,0x134806c8,0x0,0xafc0870,0x21901c90,0x18480bc8,0x0
.long 0xb4c08c0,0x21e01ce0,0x13980718,0x0,0xb9c0910,0x22301d30,0x18980c18,0x0
.long 0xbec0960,0x22801d80,0x13e80768,0x0,0xc3c09b0,0x22d01dd0,0x18e80c68,0x0
.long 0x2ac0020,0x208c1b8c,0x1e381e18,0x0,0x2fc0070,0x20dc1bdc,0x23382318,0x0
.long 0x34c00c0,0x212c1c2c,0x1e881e68,0x0,0x39c0110,0x217c1c7c,0x23882368,0x0
.long 0x3ec0160,0x21cc1ccc,0x1ed81eb8,0x0,0x43c01b0,0x221c1d1c,0x23d823b8,0x0
.long 0x48c0200,0x226c1d6c,0x1f281f08,0x0,0x4dc0250,0x22bc1dbc,0x24282408,0x0
.long 0x52c02a0,0x230c1e0c,0x1f781f58,0x0,0x57c02f0,0x235c1e5c,0x24782458,0x0
.long 0x5cc0340,0x23ac1eac,0x1fc81fa8,0x0,0x61c0390,0x23fc1efc,0x24c824a8,0x0
.long 0x66c03e0,0x244c1f4c,0x20181ff8,0x0,0x6bc0430,0x249c1f9c,0x251824f8,0x0
.long 0x70c0480,0x24ec1fec,0x20682048,0x0,0x75c04d0,0x253c203c,0x25682548,0x0
.long 0x7ac0520,0x20ac1bac,0x26902690,0x0,0x7fc0570,0x20fc1bfc,0x26942694,0x0
.long 0x84c05c0,0x214c1c4c,0x26982698,0x0,0x89c0610,0x219c1c9c,0x269c269c,0x0
.long 0x8ec0660,0x21ec1cec,0x26a026a0,0x0,0x93c06b0,0x223c1d3c,0x26a426a4,0x0
.long 0x98c0700,0x228c1d8c,0x26a826a8,0x0,0x9dc0750,0x22dc1ddc,0x26ac26ac,0x0
.long 0xa2c07a0,0x232c1e2c,0x26b026b0,0x0,0xa7c07f0,0x237c1e7c,0x26b426b4,0x0
.long 0xacc0840,0x23cc1ecc,0x26b826b8,0x0,0xb1c0890,0x241c1f1c,0x26bc26bc,0x0
.long 0xb6c08e0,0x246c1f6c,0x26c026c0,0x0,0xbbc0930,0x24bc1fbc,0x26c426c4,0x0
.long 0xc0c0980,0x250c200c,0x26c826c8,0x0,0xc5c09d0,0x255c205c,0x26cc26cc,0x0
.long 0x100a00,0x1b842300,0x14180798,0x0,0x600a50,0x1bd42350,0xc9c001c,0x0
.long 0xb00aa0,0x1c2423a0,0x146807e8,0x0,0x1000af0,0x1c7423f0,0xcec006c,0x0
.long 0x1500b40,0x1cc42440,0x14b80838,0x0,0x1a00b90,0x1d142490,0xd3c00bc,0x0
.long 0x1f00be0,0x1d6424e0,0x15080888,0x0,0x2400c30,0x1db42530,0xd8c010c,0x0
.long 0x2900004,0x1e041904,0x155808d8,0x0,0x2e00054,0x1e541954,0xddc015c,0x0
.long 0x33000a4,0x1ea419a4,0x15a80928,0x0,0x38000f4,0x1ef419f4,0xe2c01ac,0x0
.long 0x3d00144,0x1f441a44,0x15f80978,0x0,0x4200194,0x1f941a94,0xe7c01fc,0x0
.long 0x47001e4,0x1fe41ae4,0x164809c8,0x0,0x4c00234,0x20341b34,0xecc024c,0x0
.long 0x5100284,0x1ba42320,0x143807b8,0x0,0x56002d4,0x1bf42370,0xcbc003c,0x0
.long 0x5b00324,0x1c4423c0,0x14880808,0x0,0x6000374,0x1c942410,0xd0c008c,0x0
.long 0x65003c4,0x1ce42460,0x14d80858,0x0,0x6a00414,0x1d3424b0,0xd5c00dc,0x0
.long 0x6f00464,0x1d842500,0x152808a8,0x0,0x74004b4,0x1dd42550,0xdac012c,0x0
.long 0x7900504,0x1e241924,0x157808f8,0x0,0x7e00554,0x1e741974,0xdfc017c,0x0
.long 0x83005a4,0x1ec419c4,0x15c80948,0x0,0x88005f4,0x1f141a14,0xe4c01cc,0x0
.long 0x8d00644,0x1f641a64,0x16180998,0x0,0x9200694,0x1fb41ab4,0xe9c021c,0x0
.long 0x97006e4,0x20041b04,0x166809e8,0x0,0x9c00734,0x20541b54,0xeec026c,0x0
.long 0x300a20,0x1e101910,0x20b82098,0x0,0x800a70,0x1e601960,0x193c191c,0x0
.long 0xd00ac0,0x1eb019b0,0x210820e8,0x0,0x1200b10,0x1f001a00,0x198c196c,0x0
.long 0x1700b60,0x1f501a50,0x21582138,0x0,0x1c00bb0,0x1fa01aa0,0x19dc19bc,0x0
.long 0x2100c00,0x1ff01af0,0x21a82188,0x0,0x2600c50,0x20401b40,0x1a2c1a0c,0x0
.long 0x2b00024,0x20901b90,0x21f821d8,0x0,0x3000074,0x20e01be0,0x1a7c1a5c,0x0
.long 0x35000c4,0x21301c30,0x22482228,0x0,0x3a00114,0x21801c80,0x1acc1aac,0x0
.long 0x3f00164,0x21d01cd0,0x22982278,0x0,0x44001b4,0x22201d20,0x1b1c1afc,0x0
.long 0x4900204,0x22701d70,0x22e822c8,0x0,0x4e00254,0x22c01dc0,0x1b6c1b4c,0x0
.long 0x53002a4,0x1e301930,0x26902690,0x0,0x58002f4,0x1e801980,0x26942694,0x0
.long 0x5d00344,0x1ed019d0,0x26982698,0x0,0x6200394,0x1f201a20,0x269c269c,0x0
.long 0x67003e4,0x1f701a70,0x26a026a0,0x0,0x6c00434,0x1fc01ac0,0x26a426a4,0x0
.long 0x7100484,0x20101b10,0x26a826a8,0x0,0x76004d4,0x20601b60,0x26ac26ac,0x0
.long 0x7b00524,0x20b01bb0,0x26b026b0,0x0,0x8000574,0x21001c00,0x26b426b4,0x0
.long 0x85005c4,0x21501c50,0x26b826b8,0x0,0x8a00614,0x21a01ca0,0x26bc26bc,0x0
.long 0x8f00664,0x21f01cf0,0x26c026c0,0x0,0x94006b4,0x22401d40,0x26c426c4,0x0
.long 0x9900704,0x22901d90,0x26c826c8,0x0,0x9e00754,0x22e01de0,0x26cc26cc,0x0
.long 0xa100784,0x19082084,0xf1c029c,0x0,0xa6007d4,0x195820d4,0x141c079c,0x0
.long 0xab00824,0x19a82124,0xf6c02ec,0x0,0xb000874,0x19f82174,0x146c07ec,0x0
.long 0xb5008c4,0x1a4821c4,0xfbc033c,0x0,0xba00914,0x1a982214,0x14bc083c,0x0
.long 0xbf00964,0x1ae82264,0x100c038c,0x0,0xc4009b4,0x1b3822b4,0x150c088c,0x0
.long 0x140a04,0x1b882304,0x105c03dc,0x0,0x640a54,0x1bd82354,0x155c08dc,0x0
.long 0xb40aa4,0x1c2823a4,0x10ac042c,0x0,0x1040af4,0x1c7823f4,0x15ac092c,0x0
.long 0x1540b44,0x1cc82444,0x10fc047c,0x0,0x1a40b94,0x1d182494,0x15fc097c,0x0
.long 0x1f40be4,0x1d6824e4,0x114c04cc,0x0,0x2440c34,0x1db82534,0x164c09cc,0x0
.long 0x2940008,0x192820a4,0xf3c02bc,0x0,0x2e40058,0x197820f4,0x143c07bc,0x0
.long 0x33400a8,0x19c82144,0xf8c030c,0x0,0x38400f8,0x1a182194,0x148c080c,0x0
.long 0x3d40148,0x1a6821e4,0xfdc035c,0x0,0x4240198,0x1ab82234,0x14dc085c,0x0
.long 0x47401e8,0x1b082284,0x102c03ac,0x0,0x4c40238,0x1b5822d4,0x152c08ac,0x0
.long 0x5140288,0x1ba82324,0x107c03fc,0x0,0x56402d8,0x1bf82374,0x157c08fc,0x0
.long 0x5b40328,0x1c4823c4,0x10cc044c,0x0,0x6040378,0x1c982414,0x15cc094c,0x0
.long 0x65403c8,0x1ce82464,0x111c049c,0x0,0x6a40418,0x1d3824b4,0x161c099c,0x0
.long 0x6f40468,0x1d882504,0x116c04ec,0x0,0x74404b8,0x1dd82554,0x166c09ec,0x0
.long 0xa3007a4,0x1b942310,0x1bbc1b9c,0x0,0xa8007f4,0x1be42360,0x20bc209c,0x0
.long 0xad00844,0x1c3423b0,0x1c0c1bec,0x0,0xb200894,0x1c842400,0x210c20ec,0x0
.long 0xb7008e4,0x1cd42450,0x1c5c1c3c,0x0,0xbc00934,0x1d2424a0,0x215c213c,0x0
.long 0xc100984,0x1d7424f0,0x1cac1c8c,0x0,0xc6009d4,0x1dc42540,0x21ac218c,0x0
.long 0x340a24,0x1e141914,0x1cfc1cdc,0x0,0x840a74,0x1e641964,0x21fc21dc,0x0
.long 0xd40ac4,0x1eb419b4,0x1d4c1d2c,0x0,0x1240b14,0x1f041a04,0x224c222c,0x0
.long 0x1740b64,0x1f541a54,0x1d9c1d7c,0x0,0x1c40bb4,0x1fa41aa4,0x229c227c,0x0
.long 0x2140c04,0x1ff41af4,0x1dec1dcc,0x0,0x2640c54,0x20441b44,0x22ec22cc,0x0
.long 0x2b40028,0x1bb42330,0x26902690,0x0,0x3040078,0x1c042380,0x26942694,0x0
.long 0x35400c8,0x1c5423d0,0x26982698,0x0,0x3a40118,0x1ca42420,0x269c269c,0x0
.long 0x3f40168,0x1cf42470,0x26a026a0,0x0,0x44401b8,0x1d4424c0,0x26a426a4,0x0
.long 0x4940208,0x1d942510,0x26a826a8,0x0,0x4e40258,0x1de42560,0x26ac26ac,0x0
.long 0x53402a8,0x1e341934,0x26b026b0,0x0,0x58402f8,0x1e841984,0x26b426b4,0x0
.long 0x5d40348,0x1ed419d4,0x26b826b8,0x0,0x6240398,0x1f241a24,0x26bc26bc,0x0
.long 0x67403e8,0x1f741a74,0x26c026c0,0x0,0x6c40438,0x1fc41ac4,0x26c426c4,0x0
.long 0x7140488,0x20141b14,0x26c826c8,0x0,0x76404d8,0x20641b64,0x26cc26cc,0x0
.long 0x7940508,0x23081e08,0x119c051c,0x0,0x7e40558,0x23581e58,0x169c0a1c,0x0
.long 0x83405a8,0x23a81ea8,0x11ec056c,0x0,0x88405f8,0x23f81ef8,0x16ec0a6c,0x0
.long 0x8d40648,0x24481f48,0x123c05bc,0x0,0x9240698,0x24981f98,0x173c0abc,0x0
.long 0x97406e8,0x24e81fe8,0x128c060c,0x0,0x9c40738,0x25382038,0x178c0b0c,0x0
.long 0xa140788,0x190c2088,0x12dc065c,0x0,0xa6407d8,0x195c20d8,0x17dc0b5c,0x0
.long 0xab40828,0x19ac2128,0x132c06ac,0x0,0xb040878,0x19fc2178,0x182c0bac,0x0
.long 0xb5408c8,0x1a4c21c8,0x137c06fc,0x0,0xba40918,0x1a9c2218,0x187c0bfc,0x0
.long 0xbf40968,0x1aec2268,0x13cc074c,0x0,0xc4409b8,0x1b3c22b8,0x18cc0c4c,0x0
.long 0x180a08,0x23281e28,0x11bc053c,0x0,0x680a58,0x23781e78,0x16bc0a3c,0x0
.long 0xb80aa8,0x23c81ec8,0x120c058c,0x0,0x1080af8,0x24181f18,0x170c0a8c,0x0
.long 0x1580b48,0x24681f68,0x125c05dc,0x0,0x1a80b98,0x24b81fb8,0x175c0adc,0x0
.long 0x1f80be8,0x25082008,0x12ac062c,0x0,0x2480c38,0x25582058,0x17ac0b2c,0x0
.long 0x298000c,0x192c20a8,0x12fc067c,0x0,0x2e8005c,0x197c20f8,0x17fc0b7c,0x0
.long 0x33800ac,0x19cc2148,0x134c06cc,0x0,0x38800fc,0x1a1c2198,0x184c0bcc,0x0
.long 0x3d8014c,0x1a6c21e8,0x139c071c,0x0,0x428019c,0x1abc2238,0x189c0c1c,0x0
.long 0x47801ec,0x1b0c2288,0x13ec076c,0x0,0x4c8023c,0x1b5c22d8,0x18ec0c6c,0x0
.long 0x7b40528,0x19182094,0x1e3c1e1c,0x0,0x8040578,0x196820e4,0x233c231c,0x0
.long 0x85405c8,0x19b82134,0x1e8c1e6c,0x0,0x8a40618,0x1a082184,0x238c236c,0x0
.long 0x8f40668,0x1a5821d4,0x1edc1ebc,0x0,0x94406b8,0x1aa82224,0x23dc23bc,0x0
.long 0x9940708,0x1af82274,0x1f2c1f0c,0x0,0x9e40758,0x1b4822c4,0x242c240c,0x0
.long 0xa3407a8,0x1b982314,0x1f7c1f5c,0x0,0xa8407f8,0x1be82364,0x247c245c,0x0
.long 0xad40848,0x1c3823b4,0x1fcc1fac,0x0,0xb240898,0x1c882404,0x24cc24ac,0x0
.long 0xb7408e8,0x1cd82454,0x201c1ffc,0x0,0xbc40938,0x1d2824a4,0x251c24fc,0x0
.long 0xc140988,0x1d7824f4,0x206c204c,0x0,0xc6409d8,0x1dc82544,0x256c254c,0x0
.long 0x380a28,0x193820b4,0x26902690,0x0,0x880a78,0x19882104,0x26942694,0x0
.long 0xd80ac8,0x19d82154,0x26982698,0x0,0x1280b18,0x1a2821a4,0x269c269c,0x0
.long 0x1780b68,0x1a7821f4,0x26a026a0,0x0,0x1c80bb8,0x1ac82244,0x26a426a4,0x0
.long 0x2180c08,0x1b182294,0x26a826a8,0x0,0x2680c58,0x1b6822e4,0x26ac26ac,0x0
.long 0x2b8002c,0x1bb82334,0x26b026b0,0x0,0x308007c,0x1c082384,0x26b426b4,0x0
.long 0x35800cc,0x1c5823d4,0x26b826b8,0x0,0x3a8011c,0x1ca82424,0x26bc26bc,0x0
.long 0x3f8016c,0x1cf82474,0x26c026c0,0x0,0x44801bc,0x1d4824c4,0x26c426c4,0x0
.long 0x498020c,0x1d982514,0x26c826c8,0x0,0x4e8025c,0x1de82564,0x26cc26cc,0x0
```
